```python
import torch

def _softmax(x, axis=-1):
    return torch.softmax(x, dim=axis)
def _gelu(x):
    return torch.nn.functional.gelu(x, approximate="tanh")
def _silu(x):
    return torch.nn.functional.silu(x)
def _sigmoid(x):
    return torch.sigmoid(x)
def _layernorm(x, axis=-1, eps=1e-5):
    m = x.mean(dim=axis, keepdim=True)
    v = x.var(dim=axis, keepdim=True, unbiased=False)
    return (x - m) / torch.sqrt(v + eps)
def _scatter_add(tgt, idx, src, axis=0):
    return tgt.clone().index_add_(axis, idx, src)
def _segment_sum(src, seg, n):
    out = torch.zeros((n,) + src.shape[1:], dtype=src.dtype)
    return out.index_add_(0, seg, src)
def _pad(x, pw):
    flat = tuple(v for pair in reversed(pw) for v in pair)
    return torch.nn.functional.pad(x, flat)

kernel_name = 'standalone__edge_featured_mpnn_mpnn__graph'

def setup_inputs():

    _w = (lambda a: (lambda t: t.to(torch.bfloat16) if t.is_floating_point() else t)(torch.as_tensor(a)))
    N, deg, D, De = 25000, 32, 64, max(16, 1)
    E = N * deg
    H = 2 * D
    return {
        "x": _w((lambda *s: torch.randn(*s, dtype=torch.bfloat16) * 0.05)(N, D)),
        "e_attr": _w((lambda *s: torch.randn(*s, dtype=torch.bfloat16) * 0.8)(E, De)),
        "src": _w((lambda lo, hi, *s: torch.randint(lo, hi, s))(0, N, E).to(torch.int64)),
        "dst": _w((lambda lo, hi, *s: torch.randint(lo, hi, s))(0, N, E).to(torch.int64)),
        "w1": _w((lambda *s: torch.randn(*s, dtype=torch.bfloat16) * 0.8)(2 * D + De, H) * (1.0 / (2 * D + De) ** 0.5)),
        "b1": _w((lambda *s: torch.randn(*s, dtype=torch.bfloat16) * 0.8)(H) * 0.01),
        "w2": _w((lambda *s: torch.randn(*s, dtype=torch.bfloat16) * 0.05)(H, D) * (1.0 / H ** 0.5)),
        "b2": _w((lambda *s: torch.randn(*s, dtype=torch.bfloat16) * 0.05)(D) * 0.01),
    }

def reference(x, e_attr, src, dst, w1, b1, w2, b2):
    N, D = x.shape
    h_src = x[src]
    h_dst = x[dst]
    m_in = torch.concatenate([h_src, h_dst, e_attr], axis=-1)
    h = _silu(m_in @ w1 + b1)
    msg = h @ w2 + b2
    return _segment_sum(msg, dst, N)
```

```asm
; @launch grid=(256,1,1) block=(512,1,1) lds=163840
.amdgcn_target "amdgcn-amd-amdhsa--gfx950"
.text
.globl standalone__edge_featured_mpnn_mpnn__graph_kernel
.p2align 8
.type standalone__edge_featured_mpnn_mpnn__graph_kernel,@function
standalone__edge_featured_mpnn_mpnn__graph_kernel:
    s_load_dwordx2 s[24:25], s[0:1], 24
    s_load_dwordx2 s[20:21], s[0:1], 16
    s_load_dwordx2 s[90:91], s[0:1], 72
    s_getpc_b64 s[40:41]
K_pc:
    s_bfe_u32 s3, s2, 131075
    v_lshl_add_u32 v1, v0, 2, s3
    v_lshlrev_b32 v1, 7, v1
    v_min_u32 v1, K_last-K_pc, v1
    global_load_dword v120, v1, s[40:41]
    s_load_dwordx2 s[4:5], s[0:1], 0
    s_load_dwordx2 s[8:9], s[0:1], 8
    s_load_dwordx2 s[12:13], s[0:1], 80
    s_load_dwordx2 s[16:17], s[0:1], 64
    s_load_dwordx8 s[80:87], s[0:1], 32
    s_memrealtime s[38:39]
    s_cmp_ge_u32 s2, 256
    s_cbranch_scc1 K_done
    s_setprio 2
    v_lshrrev_b32 v1, 6, v0
    v_and_b32 v255, 63, v0
    v_readfirstlane_b32 s28, v1
    v_lshlrev_b32 v231, 4, v0
    v_lshlrev_b32 v3, 3, v0
    v_add_u32 v3, 8192, v3
    v_lshlrev_b32 v2, 2, v0
    v_add_u32 v4, 12288, v2
    v_mov_b32 v5, 2130706432
    v_cmp_gt_u32 vcc, 53, v0
    s_nop 1
    v_cndmask_b32_e64 v4, v5, v4, vcc
    v_mov_b32 v250, 0
    v_and_b32 v2, 1023, v2
    ds_write_b32 v2, v250 offset:39312
    s_and_b32 s29, s2, 7
    s_lshl_b32 s29, s29, 5
    s_lshr_b32 s3, s2, 3
    s_add_u32 s29, s29, s3
    s_mul_i32 s3, s29, 12500
    s_mov_b32 s26, 3200000
    s_mov_b32 s27, 0x00020000
    s_mov_b64 s[22:23], s[26:27]
    s_or_b32 s30, s2, s28
    s_waitcnt lgkmcnt(0)
    s_cmp_lg_u32 s30, 0
    s_cbranch_scc1 K_notag
    s_or_b32 s38, s38, 1
    v_mov_b32 v6, s38
    v_mov_b32 v7, s39
    s_mov_b64 exec, 1
    global_store_dwordx2 v250, v[6:7], s[90:91] sc1
    s_mov_b64 exec, -1
K_notag:
    buffer_load_dwordx4 v[128:131], v231, s[24:27], s3 offen nt
    buffer_load_dwordx2 v[132:133], v3, s[24:27], s3 offen nt
    buffer_load_dword v134, v4, s[24:27], s3 offen nt
    buffer_load_dwordx4 v[136:139], v231, s[20:23], s3 offen nt
    buffer_load_dwordx2 v[140:141], v3, s[20:23], s3 offen nt
    buffer_load_dword v142, v4, s[20:23], s3 offen nt
    s_barrier
    s_cmp_lg_u32 s28, 0
    s_cbranch_scc1 K_nopoll0
    global_load_dwordx2 v[118:119], v250, s[90:91] sc1
K_nopoll0:
    s_mov_b64 s[6:7], s[26:27]
    s_mov_b32 s10, 25600000
    s_mov_b32 s11, s27
    s_mov_b32 s14, 16777216
    s_mov_b32 s15, s27
    s_mov_b64 s[18:19], s[26:27]
    v_lshrrev_b32 v18, 3, v0
    s_lshl_b32 s3, s29, 7
    v_and_b32 v19, 0x380, v231
    v_mul_f32 v19, 0x42000000, v19
    v_bitop3_b32 v8, s3, v231, v19 bitop3:0x96
    v_bitop3_b32 v6, v0, 7, v0 bitop3:0x0c
    v_fmaak_f32 v12, 2.0, v231, 0x9d90
    v_fmamk_f32 v8, v18, 0x47000000, v8
    v_fmamk_f32 v12, v18, 0x41800000, v12
    v_mul_f32 v6, 0x4a000000, v6
    v_mul_f32 v13, 4.0, v18
    v_xor_b32 v9, 8192, v8
    v_xor_b32 v10, 16384, v8
    v_xor_b32 v11, 24576, v8
    s_mov_b32 s76, 0xf03fffff
    v_mov_b32 v15, 0xffffff
    v_mov_b32 v5, 2097153
    s_mov_b32 s3, 0x00010c0c
    v_mul_f32 v160, 4.0, v231
    v_mul_f32 v164, 4.0, v3
    v_add_u32 v166, 49152, v231
    v_mov_b32 v7, 0xf0000000
    v_perm_b32 v160, v160, v160, s3
    v_mov_b32 v14, 0xf03fffff
    v_perm_b32 v164, v164, v164, s3
    v_add_u32 v161, 0x10000000, v160
    v_add_u32 v162, 0x20000000, v160
    v_add_u32 v163, 0x30000000, v160
    v_perm_b32 v166, v166, v166, s3
    v_add_u32 v165, 0x10000000, v164
    v_mov_b32 v58, 0x70
    s_mov_b32 s92, 200000
    s_mul_i32 s3, s28, 2576
    v_mov_b32 v249, 0x3f80
    s_add_u32 m0, s3, 41888
    v_mul_f32 v251, 0x45210000, v1
    s_lshl_b32 s3, s28, 2
    v_and_b32 v243, 16, v231
    s_lshr_b32 s1, 0x75316420, s3
    v_add_u32 v251, 40352, v251
    s_lshr_b32 s93, 0x76545467, s3
    v_and_b32 v253, 48, v255
    s_and_b32 s1, s1, 7
    v_fma_f32 v242, v253, 2.0, v243
    s_and_b32 s93, s93, 7
    v_and_b32 v253, 14, v255
    s_mov_b32 s30, 0x55555555
    v_fmamk_f32 v245, v253, 0x42400000, v251
    v_and_b32 v253, 32, v255
    s_mov_b32 s31, s30
    v_fmamk_f32 v245, v253, 0x41c00000, v245
    v_and_b32 v254, 16, v255
    s_not_b64 s[32:33], s[30:31]
    v_fmamk_f32 v245, v254, 0x40400000, v245
    s_lshl_b64 s[34:35], -1, 32
    v_add_u32 v246, v243, v251
    v_and_b32 v253, 60, v255
    s_lshl_b32 s3, s1, 5
    v_fmamk_f32 v246, v253, 0x41c00000, v246
    v_and_b32 v253, 2, v255
    v_subrev_u32 v245, s3, v245
    v_fma_f32 v246, v253, 4.0, v246
    v_add_u32 v251, v251, v254
    v_and_b32 v252, 15, v255
    s_mov_b32 s36, 0x10001
    v_and_b32 v253, 8, v255
    v_fmamk_f32 v244, v252, 0x42000000, v251
    v_fmamk_f32 v244, v253, 0x42000000, v244
    v_add_u32 v230, 1536, v244
    v_add_u32 v244, 1792, v244
    s_mov_b64 exec, s[34:35]
    v_fmamk_f32 v230, v252, 0x42c00000, v251
    v_add_u32 v244, 48, v230
    s_mov_b64 exec, -1
    s_mul_i32 s3, s1, 0x10001
    s_lshl_b32 s38, s93, 16
    s_and_b32 s39, s28, 3
    s_or_b32 s38, s38, s39
    s_lshl_b32 s38, s38, 8
    s_add_u32 s3, s3, 0x400020
    s_or_b32 s3, s3, s38
    s_add_u32 s38, s1, 94
    v_lshrrev_b32 v251, 2, v255
    v_and_b32 v252, 24, v255
    v_and_b32 v251, 8, v251
    v_subrev_u32 v252, 2, v252
    v_lshrrev_b32 v251, v251, s3
    s_lshl_b32 s39, s29, 7
    v_add_u32_sdwa v61, v252, v251 dst_sel:DWORD dst_unused:UNUSED_PAD src0_sel:DWORD src1_sel:BYTE_0
    v_add_u32_sdwa v63, v252, v251 dst_sel:DWORD dst_unused:UNUSED_PAD src0_sel:DWORD src1_sel:BYTE_2
    v_bitop3_b32 v252, v231, v255, v58 bitop3:0x28
    v_min_u32 v61, s38, v61
    v_or_b32 v252, s39, v252
    s_mov_b32 s60, s3
    v_fmamk_f32 v61, v61, 0x47000000, v252
    v_xor_b32 v252, 64, v252
    v_fmamk_f32 v63, v63, 0x47000000, v252
    s_mov_b32 s61, m0
    s_lshl_b32 m0, s28, 10
    s_nop 0
    buffer_load_dwordx4 v61, s[4:7], 0 offen lds
    s_bitset1_b32 m0, 13
    s_nop 0
    buffer_load_dwordx4 v63, s[4:7], 0 offen lds
    s_mov_b32 m0, s61
    v_mul_u32_u24 v24, 0x10001, v231
    v_add_u32 v22, 113920, v231
    s_cmp_eq_u32 s28, 0
    v_add_u32 v28, 0xff82ff81, v24
    v_add_u32 v29, 0xff86ff85, v24
    v_add_u32 v30, 0xff8aff89, v24
    v_add_u32 v31, 0xff8eff8d, v24
    v_add_u32 v44, 0x7f837f81, v24
    v_add_u32 v45, 0x7f877f85, v24
    v_add_u32 v46, 0x7f8b7f89, v24
    v_add_u32 v47, 0x7f8f7f8d, v24
    s_cselect_b64 exec, 0xff, 0
    v_mov_b64 v[28:29], 0
    v_mov_b64 v[30:31], 0
    v_mov_b64 v[44:45], 0
    v_mov_b64 v[46:47], 0
    s_mov_b64 exec, -1
    ds_write_b128 v22, v[28:31]
    ds_write_b128 v22, v[44:47] offset:32768
    v_add_u32 v40, 0x60036001, v24
    v_add_u32 v41, 0x60076005, v24
    v_add_u32 v42, 0x600b6009, v24
    v_add_u32 v43, 0x600f600d, v24
    ds_write_b128 v22, v[40:43] offset:24576
    v_cmp_gt_u32 vcc, 408, v0
    v_add_u32 v32, 0x1f831f81, v24
    v_add_u32 v33, 0x1f871f85, v24
    v_add_u32 v34, 0x1f8b1f89, v24
    v_add_u32 v35, 0x1f8f1f8d, v24
    s_mov_b64 exec, vcc
    ds_write_b128 v22, v[32:35] offset:8192
    s_mov_b64 exec, -1
    v_cmp_le_u32 vcc, 24, v0
    v_add_u32 v36, 0x40034001, v24
    v_add_u32 v37, 0x40074005, v24
    v_add_u32 v38, 0x400b4009, v24
    v_add_u32 v39, 0x400f400d, v24
    s_mov_b64 exec, vcc
    ds_write_b128 v22, v[36:39] offset:16384
    s_mov_b64 exec, -1
    v_cmp_gt_u32 vcc, 432, v0
    v_add_u32 v48, 0x9f839f81, v24
    v_add_u32 v49, 0x9f879f85, v24
    v_add_u32 v50, 0x9f8b9f89, v24
    v_add_u32 v51, 0x9f8f9f8d, v24
    s_mov_b64 exec, vcc
    ds_write_b128 v22, v[48:51] offset:40960
    s_mov_b64 exec, -1
    s_add_u32 s3, s28, 7
    s_and_b32 s3, s3, 7
    s_xor_b32 s38, s28, 4
    s_mul_i32 s3, s3, 2176
    s_mul_i32 s38, s38, 2176
    s_add_u32 s3, s3, 61072
    s_add_u32 s38, s38, 84752
    v_lshl_add_u32 v56, v255, 2, s3
    v_mov_b32 v57, -1
    s_mov_b64 exec, s[34:35]
    v_lshl_add_u32 v56, v255, 2, s38
    s_mov_b64 exec, -1
    s_cmp_lg_u32 s28, 3
    s_cbranch_scc1 K_noz
    v_lshrrev_b32 v16, 1, v255
    v_mul_f32 v20, 4.0, v255
    v_mul_f32 v17, 0x45080000, v16
    v_mul_f32 v18, 0x44400000, v16
    v_add_u32 v17, 28304, v17
    v_add_u32 v18, 0x500b290, v18
    v_cndmask_b32_e64 v17, v17, v18, s[32:33]
    s_mov_b64 exec, 0xffff
    ds_write_b32 v20, v17 offset:36864
    ds_write_b32 v20, v250 offset:36928
    s_mov_b64 exec, -1
K_noz:
    v_lshrrev_b32 v52, 3, v231
    v_lshrrev_b32 v53, 1, v0
    v_and_b32 v52, 0x60, v52
    v_xor_b32 v53, v53, v0
    v_lshrrev_b32 v54, 2, v231
    v_and_b32 v53, 0x80, v53
    v_and_b32 v55, 252, v54
    v_bitop3_b32 v52, v52, v53, v231 bitop3:0x96
    v_and_b32 v60, 0xf0, v231
    v_lshrrev_b32 v54, 2, v0
    v_mul_f32 v60, 0x40400000, v60
    v_and_b32 v54, 28, v54
    v_add_u32 v54, v54, v60
    v_and_b32 v20, 31, v255
    v_and_b32 v21, 12, v255
    v_mul_f32 v20, 0x41000000, v20
    v_and_b32 v22, 48, v255
    v_fmamk_f32 v20, v21, 0x42800000, v20
    v_and_b32 v21, 16, v255
    v_fmamk_f32 v212, v22, 0x43800000, v20
    v_fmamk_f32 v59, v22, 0x42000000, v20
    v_xor_b32 v213, 32, v212
    v_xor_b32 v214, 64, v212
    v_xor_b32 v215, 96, v212
    v_xor_b32 v216, 128, v212
    v_xor_b32 v217, 160, v212
    v_xor_b32 v218, 192, v212
    v_xor_b32 v219, 224, v212
    v_fmamk_f32 v59, v21, 0x42c00000, v59
    v_cmp_gt_u32 s[38:39], 53, v0
    s_waitcnt vmcnt(5)
    v_and_b32 v144, 255, v128
    v_and_b32 v145, 255, v129
    v_and_b32 v146, 255, v130
    v_and_b32 v147, 255, v131
    v_and_b32 v148, 255, v132
    v_and_b32 v149, 255, v133
    v_and_b32 v150, 255, v134
    v_mul_f32 v168, 4.0, v144
    ds_add_rtn_u32 v152, v168, v5 offset:39312
    v_mul_f32 v169, 4.0, v145
    ds_add_rtn_u32 v153, v169, v5 offset:39312
    v_mul_f32 v170, 4.0, v146
    ds_add_rtn_u32 v154, v170, v5 offset:39312
    v_mul_f32 v171, 4.0, v147
    ds_add_rtn_u32 v155, v171, v5 offset:39312
    v_mul_f32 v172, 4.0, v148
    ds_add_rtn_u32 v156, v172, v5 offset:39312
    v_mul_f32 v173, 4.0, v149
    ds_add_rtn_u32 v157, v173, v5 offset:39312
    v_mul_f32 v174, 4.0, v150
    s_mov_b64 exec, s[38:39]
    ds_add_rtn_u32 v158, v174, v5 offset:39312
    s_mov_b64 exec, -1
    v_add_u32 v128, 25088, v128
    v_lshrrev_b32 v16, 4, v128
    v_lshrrev_b32 v128, 11, v128
    v_mul_f32 v144, 0x43880000, v144
    v_bitop3_b32 v128, v58, v16, v128 bitop3:0xca
    v_add_u32 v129, 25088, v129
    v_lshrrev_b32 v17, 4, v129
    v_lshrrev_b32 v129, 11, v129
    v_mul_f32 v145, 0x43880000, v145
    v_bitop3_b32 v129, v58, v17, v129 bitop3:0xca
    v_add_u32 v130, 25088, v130
    v_lshrrev_b32 v18, 4, v130
    v_lshrrev_b32 v130, 11, v130
    v_mul_f32 v146, 0x43880000, v146
    v_bitop3_b32 v130, v58, v18, v130 bitop3:0xca
    v_add_u32 v131, 25088, v131
    v_lshrrev_b32 v19, 4, v131
    v_lshrrev_b32 v131, 11, v131
    v_mul_f32 v147, 0x43880000, v147
    v_bitop3_b32 v131, v58, v19, v131 bitop3:0xca
    v_add_u32 v132, 25088, v132
    v_lshrrev_b32 v20, 4, v132
    v_lshrrev_b32 v132, 11, v132
    v_mul_f32 v148, 0x43880000, v148
    v_bitop3_b32 v132, v58, v20, v132 bitop3:0xca
    v_add_u32 v133, 25088, v133
    v_lshrrev_b32 v21, 4, v133
    v_lshrrev_b32 v133, 11, v133
    v_mul_f32 v149, 0x43880000, v149
    v_bitop3_b32 v133, v58, v21, v133 bitop3:0xca
    v_add_u32 v134, 25088, v134
    v_lshrrev_b32 v22, 4, v134
    v_lshrrev_b32 v134, 11, v134
    v_mul_f32 v150, 0x43880000, v150
    v_bitop3_b32 v134, v58, v22, v134 bitop3:0xca
    s_waitcnt lgkmcnt(6)
    v_and_b32 v168, 7, v152
    v_and_b32 v152, 56, v152
    v_fmamk_f32 v144, v168, 0x42000000, v144
    v_fmamk_f32 v168, v152, 0x3e000000, v144
    v_fma_f32 v144, v152, 0.5, v144
    ds_write_b8_d16_hi v168, v160 offset:40336
    s_waitcnt lgkmcnt(6)
    v_and_b32 v169, 7, v153
    v_and_b32 v153, 56, v153
    v_fmamk_f32 v145, v169, 0x42000000, v145
    v_fmamk_f32 v169, v153, 0x3e000000, v145
    v_fma_f32 v145, v153, 0.5, v145
    ds_write_b8_d16_hi v169, v161 offset:40336
    s_waitcnt lgkmcnt(6)
    v_and_b32 v170, 7, v154
    v_and_b32 v154, 56, v154
    v_fmamk_f32 v146, v170, 0x42000000, v146
    v_fmamk_f32 v170, v154, 0x3e000000, v146
    v_fma_f32 v146, v154, 0.5, v146
    ds_write_b8_d16_hi v170, v162 offset:40336
    s_waitcnt lgkmcnt(6)
    v_and_b32 v171, 7, v155
    v_and_b32 v155, 56, v155
    v_fmamk_f32 v147, v171, 0x42000000, v147
    v_fmamk_f32 v171, v155, 0x3e000000, v147
    v_fma_f32 v147, v155, 0.5, v147
    ds_write_b8_d16_hi v171, v163 offset:40336
    s_waitcnt lgkmcnt(6)
    v_and_b32 v172, 7, v156
    v_and_b32 v156, 56, v156
    v_fmamk_f32 v148, v172, 0x42000000, v148
    v_fmamk_f32 v172, v156, 0x3e000000, v148
    v_fma_f32 v148, v156, 0.5, v148
    ds_write_b8_d16_hi v172, v164 offset:40336
    s_waitcnt lgkmcnt(6)
    v_and_b32 v173, 7, v157
    v_and_b32 v157, 56, v157
    v_fmamk_f32 v149, v173, 0x42000000, v149
    v_fmamk_f32 v173, v157, 0x3e000000, v149
    v_fma_f32 v149, v157, 0.5, v149
    ds_write_b8_d16_hi v173, v165 offset:40336
    s_waitcnt lgkmcnt(6)
    v_and_b32 v174, 7, v158
    v_and_b32 v158, 56, v158
    v_fmamk_f32 v150, v174, 0x42000000, v150
    v_fmamk_f32 v174, v158, 0x3e000000, v150
    v_fma_f32 v150, v158, 0.5, v150
    s_mov_b64 exec, s[38:39]
    ds_write_b8_d16_hi v174, v166 offset:40336
    s_mov_b64 exec, -1
    s_waitcnt vmcnt(2)
K_ml:
    v_fmamk_f32 v128, v136, 0x43000000, v128
    v_fmamk_f32 v129, v137, 0x43000000, v129
    v_fmamk_f32 v130, v138, 0x43000000, v130
    v_fmamk_f32 v131, v139, 0x43000000, v131
    v_fmamk_f32 v132, v140, 0x43000000, v132
    v_fmamk_f32 v133, v141, 0x43000000, v133
    v_fmamk_f32 v134, v142, 0x43000000, v134
    v_bitop3_b32 v128, v160, v7, v128 bitop3:0xea
    ds_write_b32 v144, v128 offset:40340
    v_bitop3_b32 v129, v161, v7, v129 bitop3:0xea
    ds_write_b32 v145, v129 offset:40340
    v_bitop3_b32 v130, v162, v7, v130 bitop3:0xea
    ds_write_b32 v146, v130 offset:40340
    v_bitop3_b32 v131, v163, v7, v131 bitop3:0xea
    ds_write_b32 v147, v131 offset:40340
    v_bitop3_b32 v132, v164, v7, v132 bitop3:0xea
    ds_write_b32 v148, v132 offset:40340
    v_bitop3_b32 v133, v165, v7, v133 bitop3:0xea
    ds_write_b32 v149, v133 offset:40340
    v_bitop3_b32 v134, v166, v7, v134 bitop3:0xea
    s_mov_b64 exec, s[38:39]
    ds_write_b32 v150, v134 offset:40340
    s_mov_b64 exec, -1
    s_cmp_ge_u32 s28, 4
    s_cbranch_scc1 K_now0
    v_add_u32 v48, 32768, v231
    global_load_dwordx4 v[112:115], v48, s[80:81]
    v_and_b32 v50, 127, v0
    v_lshlrev_b32 v51, 1, v50
    global_load_ushort v116, v51, s[82:83]
    v_lshlrev_b32 v51, 1, v255
    global_load_ushort v117, v51, s[86:87]
K_now0:
    global_load_dwordx4 v[96:99], v231, s[80:81]
    v_add_u32 v48, 8192, v231
    global_load_dwordx4 v[100:103], v48, s[80:81]
    v_add_u32 v48, 16384, v231
    global_load_dwordx4 v[104:107], v48, s[80:81]
    v_add_u32 v48, 24576, v231
    global_load_dwordx4 v[108:111], v48, s[80:81]
    s_mov_b32 s0, 0
    s_mov_b64 s[64:65], 0
    s_mov_b64 s[66:67], 0
    s_mov_b64 s[68:69], 0
    s_mov_b64 s[70:71], 0
    s_cmp_eq_u32 s28, 2
    s_cbranch_scc1 K_late_chk
    s_mov_b64 vcc, 0
    s_cmp_eq_u32 s28, 1
    s_cselect_b64 exec, 0, -1
    s_cbranch_scc1 K_plate
K_dry:
    s_mov_b64 exec, -1
    s_cmp_lg_u32 s28, 0
    s_cbranch_scc1 K_tagok
K_tagpoll:
    v_readfirstlane_b32 s3, v118
    s_nop 0
    s_cmp_lg_u32 s3, 0
    s_cbranch_scc1 K_taggot
    s_sub_u32 s92, s92, 1
    s_cbranch_scc1 K_taggot
    global_load_dwordx2 v[118:119], v250, s[90:91] sc1
    s_waitcnt vmcnt(0)
    s_branch K_tagpoll
K_taggot:
    s_mov_b32 s3, 0x9e3779b1
    v_mul_lo_u32 v119, s3, v119
    v_xor_b32 v118, v118, v119
    v_mul_lo_u32 v118, s3, v118
    s_mov_b32 s3, 0x0fc00000
    v_and_b32 v124, 0xf0000000, v118
    v_lshlrev_b32 v126, 6, v118
    v_lshlrev_b32 v127, 12, v118
    v_and_b32 v125, s3, v118
    v_and_b32 v126, s3, v126
    v_and_b32 v127, s3, v127
    ds_write_b128 v250, v[124:127] offset:39296
K_tagok:
    s_waitcnt lgkmcnt(0)
    s_barrier
    ds_read_b128 v[124:127], v250 offset:39296
    ds_read_b32 v204, v13 offset:39312
    ds_read_b32 v205, v13 offset:39568
    ds_read_b32 v206, v13 offset:39824
    ds_read_b32 v207, v13 offset:40080
    ds_read_b128 v[180:183], v12 offset:0
    ds_read_b128 v[184:187], v12 offset:17408
    ds_read_b128 v[188:191], v12 offset:34816
    ds_read_b128 v[192:195], v12 offset:52224
    s_waitcnt lgkmcnt(8)
    v_add_u32 v6, v6, v124
    v_or_b32 v2, 0x8000000, v124
    s_waitcnt lgkmcnt(7)
    v_add_u32 v208, v204, v6
    v_and_b32 v204, 0xfff, v204
    v_sub_u32 v152, 32, v204
    v_bitop3_b32 v208, v152, v2, v208 bitop3:0xca
    s_waitcnt lgkmcnt(6)
    v_add_u32 v209, v205, v6
    v_and_b32 v205, 0xfff, v205
    v_sub_u32 v153, 32, v205
    v_bitop3_b32 v209, v153, v2, v209 bitop3:0xca
    s_waitcnt lgkmcnt(5)
    v_add_u32 v210, v206, v6
    v_and_b32 v206, 0xfff, v206
    v_sub_u32 v154, 32, v206
    v_bitop3_b32 v210, v154, v2, v210 bitop3:0xca
    s_waitcnt lgkmcnt(4)
    v_add_u32 v211, v207, v6
    v_and_b32 v207, 0xfff, v207
    v_sub_u32 v155, 32, v207
    v_bitop3_b32 v211, v155, v2, v211 bitop3:0xca
    s_waitcnt lgkmcnt(3)
    v_bitop3_b32 v180, v15, v180, v208 bitop3:0xca
    v_bitop3_b32 v181, v181, v14, v125 bitop3:0xea
    v_bitop3_b32 v182, v182, v14, v126 bitop3:0xea
    v_bitop3_b32 v183, v183, v14, v127 bitop3:0xea
    s_mov_b32 s3, 0
    buffer_store_dwordx4 v[180:183], v8, s[12:15], s3 offen sc1
    s_waitcnt lgkmcnt(2)
    v_bitop3_b32 v184, v15, v184, v209 bitop3:0xca
    v_bitop3_b32 v185, v185, v14, v125 bitop3:0xea
    v_bitop3_b32 v186, v186, v14, v126 bitop3:0xea
    v_bitop3_b32 v187, v187, v14, v127 bitop3:0xea
    s_mov_b32 s3, 2097152
    buffer_store_dwordx4 v[184:187], v9, s[12:15], s3 offen sc1
    s_waitcnt lgkmcnt(1)
    v_bitop3_b32 v188, v15, v188, v210 bitop3:0xca
    v_bitop3_b32 v189, v189, v14, v125 bitop3:0xea
    v_bitop3_b32 v190, v190, v14, v126 bitop3:0xea
    v_bitop3_b32 v191, v191, v14, v127 bitop3:0xea
    s_mov_b32 s3, 4194304
    buffer_store_dwordx4 v[188:191], v10, s[12:15], s3 offen sc1
    s_waitcnt lgkmcnt(0)
    v_bitop3_b32 v192, v15, v192, v211 bitop3:0xca
    v_bitop3_b32 v193, v193, v14, v125 bitop3:0xea
    v_bitop3_b32 v194, v194, v14, v126 bitop3:0xea
    v_bitop3_b32 v195, v195, v14, v127 bitop3:0xea
    s_mov_b32 s3, 6291456
    buffer_store_dwordx4 v[192:195], v11, s[12:15], s3 offen sc1
    v_or3_b32 v152, v208, v209, v210
    v_or_b32 v152, v152, v211
    v_readfirstlane_b32 s72, v124
    v_readfirstlane_b32 s73, v125
    v_readfirstlane_b32 s74, v126
    v_readfirstlane_b32 s75, v127
    v_and_b32 v152, 0x4000000, v152
    v_cmp_ne_u32 vcc, 0, v152
    s_nop 0
    s_cbranch_vccnz K_plate
    s_waitcnt vmcnt(4)
K_pubdone:
    s_setprio 0
    ds_write_b32 v56, v57
    v_and_b32 v16, 7, v255
    v_and_b32 v17, 8, v255
    v_and_b32 v18, 0x1c00, v231
    v_lshrrev_b32 v19, 1, v231
    v_fmamk_f32 v18, v16, 0x43000000, v18
    v_and_b32 v16, 96, v242
    v_fmamk_f32 v18, v17, 0x44800000, v18
    v_bitop3_b32 v16, v16, v19, v58 bitop3:0x28
    v_add_u32 v61, v18, v16
    v_xor_b32 v63, 16, v61
    ds_read_b128 v[220:223], v61
    ds_read_b128 v[224:227], v63
    s_cmp_lg_u32 s92, -1
    s_cbranch_scc1 K_hastag
    v_mov_b32 v5, 0x10000000
    ds_max_u32 v250, v5 offset:36864
    s_mov_b32 s92, 0
K_hastag:
    s_mov_b32 s3, 0x3fb8aa3b
    s_mov_b32 s38, 0xffff0000
    s_mov_b32 s88, s3
    s_mov_b32 s89, s3
    v_lshlrev_b32 v16, 16, v96
    v_and_b32 v17, s38, v96
    v_pk_mul_f32 v[16:17], v[16:17], s[88:89]
    v_cvt_pk_bf16_f32 v96, v16, v17
    v_lshlrev_b32 v18, 16, v97
    v_and_b32 v19, s38, v97
    v_pk_mul_f32 v[18:19], v[18:19], s[88:89]
    v_cvt_pk_bf16_f32 v97, v18, v19
    v_lshlrev_b32 v20, 16, v98
    v_and_b32 v21, s38, v98
    v_pk_mul_f32 v[20:21], v[20:21], s[88:89]
    v_cvt_pk_bf16_f32 v98, v20, v21
    v_lshlrev_b32 v22, 16, v99
    v_and_b32 v23, s38, v99
    v_pk_mul_f32 v[22:23], v[22:23], s[88:89]
    v_cvt_pk_bf16_f32 v99, v22, v23
    ds_write_b128 v52, v[96:99] offset:0
    v_lshlrev_b32 v16, 16, v100
    v_and_b32 v17, s38, v100
    v_pk_mul_f32 v[16:17], v[16:17], s[88:89]
    v_cvt_pk_bf16_f32 v100, v16, v17
    v_lshlrev_b32 v18, 16, v101
    v_and_b32 v19, s38, v101
    v_pk_mul_f32 v[18:19], v[18:19], s[88:89]
    v_cvt_pk_bf16_f32 v101, v18, v19
    v_lshlrev_b32 v20, 16, v102
    v_and_b32 v21, s38, v102
    v_pk_mul_f32 v[20:21], v[20:21], s[88:89]
    v_cvt_pk_bf16_f32 v102, v20, v21
    v_lshlrev_b32 v22, 16, v103
    v_and_b32 v23, s38, v103
    v_pk_mul_f32 v[22:23], v[22:23], s[88:89]
    v_cvt_pk_bf16_f32 v103, v22, v23
    ds_write_b128 v52, v[100:103] offset:8192
    v_lshlrev_b32 v16, 16, v104
    v_and_b32 v17, s38, v104
    v_pk_mul_f32 v[16:17], v[16:17], s[88:89]
    v_cvt_pk_bf16_f32 v104, v16, v17
    v_lshlrev_b32 v18, 16, v105
    v_and_b32 v19, s38, v105
    v_pk_mul_f32 v[18:19], v[18:19], s[88:89]
    v_cvt_pk_bf16_f32 v105, v18, v19
    v_lshlrev_b32 v20, 16, v106
    v_and_b32 v21, s38, v106
    v_pk_mul_f32 v[20:21], v[20:21], s[88:89]
    v_cvt_pk_bf16_f32 v106, v20, v21
    v_lshlrev_b32 v22, 16, v107
    v_and_b32 v23, s38, v107
    v_pk_mul_f32 v[22:23], v[22:23], s[88:89]
    v_cvt_pk_bf16_f32 v107, v22, v23
    ds_write_b128 v52, v[104:107] offset:16384
    v_lshlrev_b32 v16, 16, v108
    v_and_b32 v17, s38, v108
    v_pk_mul_f32 v[16:17], v[16:17], s[88:89]
    v_cvt_pk_bf16_f32 v108, v16, v17
    v_lshlrev_b32 v18, 16, v109
    v_and_b32 v19, s38, v109
    v_pk_mul_f32 v[18:19], v[18:19], s[88:89]
    v_cvt_pk_bf16_f32 v109, v18, v19
    v_lshlrev_b32 v20, 16, v110
    v_and_b32 v21, s38, v110
    v_pk_mul_f32 v[20:21], v[20:21], s[88:89]
    v_cvt_pk_bf16_f32 v110, v20, v21
    v_lshlrev_b32 v22, 16, v111
    v_and_b32 v23, s38, v111
    v_pk_mul_f32 v[22:23], v[22:23], s[88:89]
    v_cvt_pk_bf16_f32 v111, v22, v23
    ds_write_b128 v52, v[108:111] offset:24576
    s_cmp_ge_u32 s28, 4
    s_cbranch_scc1 K_now5
    v_lshlrev_b32 v16, 16, v112
    v_and_b32 v17, s38, v112
    v_pk_mul_f32 v[16:17], v[16:17], s[88:89]
    v_cvt_pk_bf16_f32 v112, v16, v17
    v_lshlrev_b32 v18, 16, v113
    v_and_b32 v19, s38, v113
    v_pk_mul_f32 v[18:19], v[18:19], s[88:89]
    v_cvt_pk_bf16_f32 v113, v18, v19
    v_lshlrev_b32 v20, 16, v114
    v_and_b32 v21, s38, v114
    v_pk_mul_f32 v[20:21], v[20:21], s[88:89]
    v_cvt_pk_bf16_f32 v114, v20, v21
    v_lshlrev_b32 v22, 16, v115
    v_and_b32 v23, s38, v115
    v_pk_mul_f32 v[22:23], v[22:23], s[88:89]
    v_cvt_pk_bf16_f32 v115, v22, v23
    ds_write_b128 v52, v[112:115] offset:32768
    v_lshlrev_b32 v116, 16, v116
    v_mul_f32 v116, s3, v116
    v_lshlrev_b32 v117, 16, v117
    v_mul_f32 v117, s3, v117
    ds_write_b32 v54, v116 offset:36992
    ds_write_b32 v55, v117 offset:39040
K_now5:
    s_waitcnt lgkmcnt(0)
    s_barrier
    v_mov_b64 v[196:197], 0
    v_mov_b64 v[198:199], 0
    s_sub_u32 s3, m0, 1536
    v_mad_u32_u24 v200, v255, 24, s3
    ds_write_b64 v200, v[196:197]
    ds_write2_b64 v200, v[196:197], v[198:199] offset0:1 offset1:2
    ds_read_b128 v[40:43], v60 offset:36992
    ds_read_b128 v[44:47], v60 offset:37008
    ds_read_b64_tr_b16 v[96:97], v212 offset:16384
    ds_read_b64_tr_b16 v[98:99], v212 offset:17408
    ds_read_b64_tr_b16 v[100:101], v216 offset:18432
    ds_read_b64_tr_b16 v[102:103], v216 offset:19456
    ds_read_b64_tr_b16 v[104:105], v213 offset:16384
    ds_read_b64_tr_b16 v[106:107], v213 offset:17408
    ds_read_b64_tr_b16 v[108:109], v217 offset:18432
    ds_read_b64_tr_b16 v[110:111], v217 offset:19456
    ds_read_b64_tr_b16 v[112:113], v214 offset:16384
    ds_read_b64_tr_b16 v[114:115], v214 offset:17408
    ds_read_b64_tr_b16 v[116:117], v218 offset:18432
    ds_read_b64_tr_b16 v[118:119], v218 offset:19456
    ds_read_b64_tr_b16 v[120:121], v215 offset:16384
    ds_read_b64_tr_b16 v[122:123], v215 offset:17408
    ds_read_b64_tr_b16 v[124:125], v219 offset:18432
    ds_read_b64_tr_b16 v[126:127], v219 offset:19456
    ds_read_b64_tr_b16 v[160:161], v216 offset:16384
    ds_read_b64_tr_b16 v[162:163], v216 offset:17408
    ds_read_b64_tr_b16 v[164:165], v212 offset:18432
    ds_read_b64_tr_b16 v[166:167], v212 offset:19456
    ds_read_b64_tr_b16 v[168:169], v217 offset:16384
    ds_read_b64_tr_b16 v[170:171], v217 offset:17408
    ds_read_b64_tr_b16 v[172:173], v213 offset:18432
    ds_read_b64_tr_b16 v[174:175], v213 offset:19456
    ds_read_b64_tr_b16 v[180:181], v218 offset:16384
    ds_read_b64_tr_b16 v[182:183], v218 offset:17408
    ds_read_b64_tr_b16 v[184:185], v214 offset:18432
    ds_read_b64_tr_b16 v[186:187], v214 offset:19456
    ds_read_b64_tr_b16 v[188:189], v219 offset:16384
    ds_read_b64_tr_b16 v[190:191], v219 offset:17408
    ds_read_b64_tr_b16 v[192:193], v215 offset:18432
    ds_read_b64_tr_b16 v[194:195], v215 offset:19456
    s_mov_b64 s[56:57], s[84:85]
    s_mov_b32 s83, 0
    s_mov_b32 s77, 0
    s_lshl_b32 s50, s29, 15
    s_add_u32 s51, s50, 8192
    s_add_u32 s52, s50, 16384
    s_add_u32 s53, s50, 24576
    s_mov_b32 s48, 15
    s_mov_b32 s78, 0xc0c0403
    s_lshr_b32 s3, s73, 24
    s_sub_u32 s82, 0, s3
    s_mov_b32 s79, 0xc0c0503
    s_lshr_b32 s3, s74, 24
    s_sub_u32 s85, 0, s3
    s_mov_b32 s80, 0xc0c0603
    s_lshr_b32 s3, s75, 24
    s_sub_u32 s90, 0, s3
    s_mov_b32 s91, 0x0fc00000
    s_mov_b32 s76, 0x3fffff
    ds_read_b64_tr_b16 v[64:65], v59 offset:32768
    v_xor_b32 v33, 32, v59
    ds_read_b64_tr_b16 v[68:69], v33 offset:32768
    v_xor_b32 v34, 64, v59
    ds_read_b64_tr_b16 v[72:73], v34 offset:32768
    v_xor_b32 v35, 96, v59
    ds_read_b64_tr_b16 v[76:77], v35 offset:32768
    v_xor_b32 v36, 128, v59
    ds_read_b64_tr_b16 v[80:81], v36 offset:32768
    v_xor_b32 v37, 160, v59
    ds_read_b64_tr_b16 v[84:85], v37 offset:32768
    v_xor_b32 v38, 192, v59
    ds_read_b64_tr_b16 v[88:89], v38 offset:32768
    v_xor_b32 v39, 224, v59
    ds_read_b64_tr_b16 v[92:93], v39 offset:32768
    s_waitcnt lgkmcnt(15)
    v_pk_mov_b32 v[0:1], v[40:41], v[40:41] op_sel:[0,0]
    v_pk_mov_b32 v[2:3], v[40:41], v[40:41] op_sel:[0,0]
    v_pk_mov_b32 v[4:5], v[40:41], v[40:41] op_sel:[1,1]
    v_pk_mov_b32 v[6:7], v[40:41], v[40:41] op_sel:[1,1]
    v_pk_mov_b32 v[8:9], v[42:43], v[42:43] op_sel:[0,0]
    v_pk_mov_b32 v[10:11], v[42:43], v[42:43] op_sel:[0,0]
    v_pk_mov_b32 v[12:13], v[42:43], v[42:43] op_sel:[1,1]
    v_pk_mov_b32 v[14:15], v[42:43], v[42:43] op_sel:[1,1]
    v_pk_mov_b32 v[16:17], v[44:45], v[44:45] op_sel:[0,0]
    v_pk_mov_b32 v[18:19], v[44:45], v[44:45] op_sel:[0,0]
    v_pk_mov_b32 v[20:21], v[44:45], v[44:45] op_sel:[1,1]
    v_pk_mov_b32 v[22:23], v[44:45], v[44:45] op_sel:[1,1]
    v_pk_mov_b32 v[24:25], v[46:47], v[46:47] op_sel:[0,0]
    v_pk_mov_b32 v[26:27], v[46:47], v[46:47] op_sel:[0,0]
    v_pk_mov_b32 v[28:29], v[46:47], v[46:47] op_sel:[1,1]
    v_pk_mov_b32 v[30:31], v[46:47], v[46:47] op_sel:[1,1]
    s_waitcnt lgkmcnt(8)
    v_mfma_f32_16x16x32_bf16 v[0:3], v[220:223], v[96:99], v[0:3]
    v_mfma_f32_16x16x32_bf16 v[4:7], v[220:223], v[104:107], v[4:7]
    v_mfma_f32_16x16x32_bf16 v[8:11], v[220:223], v[112:115], v[8:11]
    v_mfma_f32_16x16x32_bf16 v[12:15], v[220:223], v[120:123], v[12:15]
    v_mfma_f32_16x16x32_bf16 v[16:19], v[220:223], v[160:163], v[16:19]
    v_mfma_f32_16x16x32_bf16 v[20:23], v[220:223], v[168:171], v[20:23]
    v_mfma_f32_16x16x32_bf16 v[24:27], v[220:223], v[180:183], v[24:27]
    v_mfma_f32_16x16x32_bf16 v[28:31], v[220:223], v[188:191], v[28:31]
    v_mfma_f32_16x16x32_bf16 v[0:3], v[224:227], v[100:103], v[0:3]
    v_mfma_f32_16x16x32_bf16 v[4:7], v[224:227], v[108:111], v[4:7]
    v_mfma_f32_16x16x32_bf16 v[8:11], v[224:227], v[116:119], v[8:11]
    v_mfma_f32_16x16x32_bf16 v[12:15], v[224:227], v[124:127], v[12:15]
    v_mfma_f32_16x16x32_bf16 v[16:19], v[224:227], v[164:167], v[16:19]
    v_mfma_f32_16x16x32_bf16 v[20:23], v[224:227], v[172:175], v[20:23]
    v_mfma_f32_16x16x32_bf16 v[24:27], v[224:227], v[184:187], v[24:27]
    v_mfma_f32_16x16x32_bf16 v[28:31], v[224:227], v[192:195], v[28:31]
    s_nop 0
    v_cvt_pk_bf16_f32 v66, v0, v1
    v_cvt_pk_bf16_f32 v67, v2, v3
    v_cvt_pk_bf16_f32 v70, v4, v5
    v_cvt_pk_bf16_f32 v71, v6, v7
    v_cvt_pk_bf16_f32 v74, v8, v9
    v_cvt_pk_bf16_f32 v75, v10, v11
    v_cvt_pk_bf16_f32 v78, v12, v13
    v_cvt_pk_bf16_f32 v79, v14, v15
    v_cvt_pk_bf16_f32 v82, v16, v17
    v_cvt_pk_bf16_f32 v83, v18, v19
    v_cvt_pk_bf16_f32 v86, v20, v21
    v_cvt_pk_bf16_f32 v87, v22, v23
    v_cvt_pk_bf16_f32 v90, v24, v25
    v_cvt_pk_bf16_f32 v91, v26, v27
    v_cvt_pk_bf16_f32 v94, v28, v29
    v_cvt_pk_bf16_f32 v95, v30, v31
    buffer_load_dwordx4 v[128:131], v231, s[12:15], s50 offen sc1
    buffer_load_dwordx4 v[132:135], v231, s[12:15], s51 offen sc1
    buffer_load_dwordx4 v[136:139], v231, s[12:15], s52 offen sc1
    buffer_load_dwordx4 v[140:143], v231, s[12:15], s53 offen sc1
K_nop2:
    v_lshrrev_b32 v0, 4, v231
    v_and_b32 v24, 256, v0
    v_fmaak_f32 v23, 0.5, v231, 0x13980
    v_fmamk_f32 v23, v24, 0x42f30000, v23
    v_lshlrev_b32 v24, 16, v23
    v_add_u32 v25, 65536, v24
    v_add_u32 v26, 196608, v24
    v_add_u32 v27, 327680, v24
    v_add_u32 v28, 458752, v24
    v_exp_f32 v32, -v25
    v_exp_f32 v33, -v26
    v_exp_f32 v34, -v27
    v_exp_f32 v35, -v28
    v_add_f32 v32, 1.0, v32
    v_add_f32 v33, 1.0, v33
    v_add_f32 v34, 1.0, v34
    v_add_f32 v35, 1.0, v35
    v_rcp_f32 v32, v32
    v_rcp_f32 v33, v33
    v_rcp_f32 v34, v34
    v_rcp_f32 v35, v35
    v_mul_f32 v32, v32, v25
    v_mul_f32 v33, v33, v26
    v_mul_f32 v34, v34, v27
    v_mul_f32 v35, v35, v28
    v_cvt_pk_bf16_f32 v32, v32, v33
    v_cvt_pk_bf16_f32 v33, v34, v35
    ds_write_b64 v23, v[32:33] offset:48384
    s_mul_i32 s3, s1, 2176
    v_and_b32 v248, 14, v255
    v_and_b32 v251, 12, v255
    s_add_u32 s3, s3, 61072
    v_fmaak_f32 v247, 4.0, v251, 0x5d00
    v_and_b32 v251, 34, v255
    v_lshl_add_u32 v248, v248, 3, s3
    v_fma_f32 v247, v251, 2.0, v247
    v_and_b32 v251, 16, v255
    v_fma_f32 v247, v251, 0.5, v247
    v_add_u32 v247, s3, v247
    v_lshrrev_b32 v251, 7, v231
    s_lshl_b32 s3, s29, 5
    s_xor_b32 s3, s3, s29
    s_and_b32 s3, s3, 255
    v_xor_b32 v236, s3, v251
    v_xor_b32 v237, 64, v236
    v_xor_b32 v238, 128, v236
    v_xor_b32 v239, 192, v236
    v_mul_f32 v236, 0x47435000, v236
    v_mul_f32 v237, 0x47435000, v237
    v_mul_f32 v238, 0x47435000, v238
    v_mul_f32 v239, 0x47435000, v239
    ds_read_b64_tr_b16 v[0:1], v212 offset:0
    ds_read_b64_tr_b16 v[2:3], v212 offset:1024
    ds_read_b64_tr_b16 v[4:5], v216 offset:2048
    ds_read_b64_tr_b16 v[6:7], v216 offset:3072
    ds_read_b64_tr_b16 v[8:9], v213 offset:0
    ds_read_b64_tr_b16 v[10:11], v213 offset:1024
    ds_read_b64_tr_b16 v[12:13], v217 offset:2048
    ds_read_b64_tr_b16 v[14:15], v217 offset:3072
    ds_read_b64_tr_b16 v[16:17], v214 offset:0
    ds_read_b64_tr_b16 v[18:19], v214 offset:1024
    ds_read_b64_tr_b16 v[20:21], v218 offset:2048
    ds_read_b64_tr_b16 v[22:23], v218 offset:3072
    ds_read_b64_tr_b16 v[24:25], v215 offset:0
    ds_read_b64_tr_b16 v[26:27], v215 offset:1024
    ds_read_b64_tr_b16 v[28:29], v219 offset:2048
    ds_read_b64_tr_b16 v[30:31], v219 offset:3072
    ds_read_b64_tr_b16 v[32:33], v216 offset:0
    ds_read_b64_tr_b16 v[34:35], v216 offset:1024
    ds_read_b64_tr_b16 v[36:37], v212 offset:2048
    ds_read_b64_tr_b16 v[38:39], v212 offset:3072
    ds_read_b64_tr_b16 v[40:41], v217 offset:0
    ds_read_b64_tr_b16 v[42:43], v217 offset:1024
    ds_read_b64_tr_b16 v[44:45], v213 offset:2048
    ds_read_b64_tr_b16 v[46:47], v213 offset:3072
    ds_read_b64_tr_b16 v[48:49], v218 offset:0
    ds_read_b64_tr_b16 v[50:51], v218 offset:1024
    ds_read_b64_tr_b16 v[52:53], v214 offset:2048
    ds_read_b64_tr_b16 v[54:55], v214 offset:3072
    ds_read_b64_tr_b16 v[56:57], v219 offset:0
    ds_read_b64_tr_b16 v[58:59], v219 offset:1024
    ds_read_b64_tr_b16 v[60:61], v215 offset:2048
    ds_read_b64_tr_b16 v[62:63], v215 offset:3072
    s_mov_b32 s3, s60
    s_add_u32 s38, s1, 94
    v_and_b32 v251, 12, v255
    v_add_u32 v251, v251, v251
    v_and_b32 v252, 3, v255
    v_bfe_u32 v251, s3, v251, 8
    v_fmamk_f32 v251, v252, 0x41000000, v251
    v_subrev_u32 v251, 2, v251
    v_and_b32 v252, 48, v255
    v_min_u32 v251, s38, v251
    v_fmamk_f32 v228, v251, 0x47000000, v252
    v_mov_b32 v251, s29
    v_fmamk_f32 v228, v251, 0x43000000, v228
    v_and_b32 v229, 7, v255
    v_mov_b32 v240, 0xda589210
    v_mul_f32 v229, 4.0, v229
    s_mov_b32 exec_lo, 0xff00ff00
    v_mov_b32 v240, 0xfe7cb634
    s_mov_b32 exec_lo, -1
    v_bfe_u32 v240, v240, v229, 4
    v_mul_f32 v240, 4.0, v240
    s_and_b32 s38, s28, 3
    s_lshl_b32 s3, s28, 2
    v_bfe_u32 v229, v255, 1, 3
    s_lshr_b32 s60, 0xe6a2c480, s3
    s_and_b32 s60, s60, 15
    v_mul_f32 v229, 0x43808000, v229
    s_add_u32 s61, s60, 15
    s_and_b32 s61, s61, 15
    v_add_u32 v229, 0x201, v229
    s_cmp_lt_u32 s28, 4
    s_cselect_b32 s62, s93, s38
    s_cselect_b32 s63, s38, s93
    s_cselect_b32 s38, 0, 0x8000000
    s_cselect_b32 s39, 0x8000000, 0
    v_lshrrev_b32 v229, 1, v229
    s_sub_u32 s55, s1, s62
    s_sub_u32 s93, s1, s63
    v_and_b32 v229, 0xffff0707, v229
    s_lshl_b32 s55, s55, 29
    s_lshl_b32 s93, s93, 29
    s_mov_b32 s3, 5242880
    v_mad_u32_u24 v229, v243, s3, v229
    s_sub_u32 s55, s55, s38
    s_sub_u32 s93, s93, s39
    s_mul_i32 s54, s1, 2176
    s_mul_i32 s62, s62, 768
    s_mul_i32 s63, s63, 768
    s_add_u32 s62, s62, 45712
    s_add_u32 s63, s63, 45712
    s_add_u32 s54, s54, 28304
    s_cmp_lt_u32 s1, 7
    s_cselect_b32 s3, 32, -2
    s_lshl_b32 s37, s1, 5
    s_add_u32 s37, s37, s3
    s_lshl_b32 s37, s37, 24
    s_or_b32 s37, s37, 0xfffff0
    s_lshl_b32 s3, s28, 10
    v_add_u32 v232, s3, v231
    global_load_dwordx4 v[176:179], v232, s[56:57]
    global_load_dwordx4 v[232:235], v232, s[56:57] offset:1024
    v_lshrrev_b32 v208, 1, v231
    s_lshl_b32 s3, s29, 12
    s_add_u32 s3, s3, 12582912
    buffer_load_dwordx2 v[210:211], v208, s[12:15], s3 offen sc1 nt
    v_mov_b32 v220, s72
    v_mov_b32 v221, s73
    v_mov_b32 v222, s74
    v_mov_b32 v223, s75
    v_mov_b32 v224, 0x0fc00000
    s_mov_b32 s3, 0x7fdca90
    v_mov_b32 v225, 262148
    v_lshl_add_u32 v226, v255, 2, s3
    v_mov_b64 v[196:197], -1
    v_mov_b64 v[198:199], -1
    v_mov_b64 v[200:201], -1
    v_mov_b64 v[202:203], -1
    v_mov_b64 v[204:205], -1
    v_mov_b64 v[206:207], -1
    v_mov_b32 v251, 0
    v_mov_b32 v252, 0
    v_mov_b32 v253, 0
    v_mov_b32 v254, 0
    s_setprio 1
    s_waitcnt vmcnt(6)
    v_xor_b32 v208, v221, v129
    v_xor_b32 v209, v220, v128
    v_bitop3_b32 v208, v130, v222, v208 bitop3:0xbe
    v_bitop3_b32 v208, v131, v223, v208 bitop3:0xbe
    v_bitop3_b32 v208, v224, v208, v209 bitop3:0xca
    v_cmp_lt_u32 s[40:41], s76, v208
    s_waitcnt vmcnt(5)
    v_xor_b32 v208, v221, v133
    v_xor_b32 v209, v220, v132
    v_bitop3_b32 v208, v134, v222, v208 bitop3:0xbe
    v_bitop3_b32 v208, v135, v223, v208 bitop3:0xbe
    v_bitop3_b32 v208, v224, v208, v209 bitop3:0xca
    v_cmp_lt_u32 s[42:43], s76, v208
    s_waitcnt vmcnt(4)
    v_xor_b32 v208, v221, v137
    v_xor_b32 v209, v220, v136
    v_bitop3_b32 v208, v138, v222, v208 bitop3:0xbe
    v_bitop3_b32 v208, v139, v223, v208 bitop3:0xbe
    v_bitop3_b32 v208, v224, v208, v209 bitop3:0xca
    v_cmp_lt_u32 s[44:45], s76, v208
    s_waitcnt vmcnt(3)
    v_xor_b32 v208, v221, v141
    v_xor_b32 v209, v220, v140
    v_bitop3_b32 v208, v142, v222, v208 bitop3:0xbe
    v_bitop3_b32 v208, v143, v223, v208 bitop3:0xbe
    v_bitop3_b32 v208, v224, v208, v209 bitop3:0xca
    v_cmp_lt_u32 s[46:47], s76, v208
    s_mov_b32 s49, s48
    s_or_b64 s[38:39], s[40:41], s[42:43]
    s_or_b64 s[88:89], s[44:45], s[46:47]
    s_or_b64 s[38:39], s[38:39], s[88:89]
    s_cbranch_scc1 K_retry2
    v_bfe_i32 v251, v128, 24, 4
    v_lshrrev_b32 v186, 1, v129
    v_or_b32 v189, -5, v129
    v_bitop3_b32 v186, v186, v189, 60 bitop3:0x80
    v_lshrrev_b32 v187, 1, v130
    v_or_b32 v190, -5, v130
    v_bitop3_b32 v187, v187, v190, 60 bitop3:0x80
    v_lshrrev_b32 v188, 1, v131
    v_or_b32 v191, -5, v131
    v_bitop3_b32 v188, v188, v191, 60 bitop3:0x80
    v_cmpx_lt_i32 vcc, 0, v251
    ds_add_rtn_u32 v196, v186, v225 offset:36864
    v_cmpx_lt_i32 vcc, 1, v251
    ds_add_rtn_u32 v197, v187, v225 offset:36864
    v_cmpx_lt_i32 vcc, 2, v251
    ds_add_rtn_u32 v198, v188, v225 offset:36864
    s_mov_b64 exec, -1
    v_perm_b32 v144, v128, v129, s78
    v_add3_u32 v144, v144, v236, s82
    v_perm_b32 v145, v128, v130, s79
    v_add3_u32 v145, v145, v236, s85
    v_perm_b32 v128, v128, v131, s80
    v_add3_u32 v128, v128, v236, s90
    v_lshl_or_b32 v144, v129, 25, v144
    v_and_b32 v129, 0x003fff80, v129
    v_lshl_or_b32 v145, v130, 25, v145
    v_and_b32 v130, 0x003fff80, v130
    v_lshl_or_b32 v128, v131, 25, v128
    v_and_b32 v131, 0x003fff80, v131
    v_bfe_i32 v252, v132, 24, 4
    v_lshrrev_b32 v186, 1, v133
    v_or_b32 v189, -5, v133
    v_bitop3_b32 v186, v186, v189, 60 bitop3:0x80
    v_lshrrev_b32 v187, 1, v134
    v_or_b32 v190, -5, v134
    v_bitop3_b32 v187, v187, v190, 60 bitop3:0x80
    v_lshrrev_b32 v188, 1, v135
    v_or_b32 v191, -5, v135
    v_bitop3_b32 v188, v188, v191, 60 bitop3:0x80
    v_cmpx_lt_i32 vcc, 0, v252
    ds_add_rtn_u32 v199, v186, v225 offset:36864
    v_cmpx_lt_i32 vcc, 1, v252
    ds_add_rtn_u32 v200, v187, v225 offset:36864
    v_cmpx_lt_i32 vcc, 2, v252
    ds_add_rtn_u32 v201, v188, v225 offset:36864
    s_mov_b64 exec, -1
    s_waitcnt lgkmcnt(3)
    v_min_u32_sdwa v196, v196, v226 dst_sel:WORD_0 dst_unused:UNUSED_PAD src0_sel:DWORD src1_sel:DWORD
    v_min_u32_sdwa v197, v197, v226 dst_sel:WORD_0 dst_unused:UNUSED_PAD src0_sel:DWORD src1_sel:DWORD
    v_min_u32_sdwa v198, v198, v226 dst_sel:WORD_0 dst_unused:UNUSED_PAD src0_sel:DWORD src1_sel:DWORD
    ds_write2st64_b32 v196, v129, v144 offset0:128 offset1:221
    ds_write2st64_b32 v197, v130, v145 offset0:128 offset1:221
    ds_write2st64_b32 v198, v131, v128 offset0:128 offset1:221
    v_perm_b32 v146, v132, v133, s78
    v_add3_u32 v146, v146, v237, s82
    v_perm_b32 v147, v132, v134, s79
    v_add3_u32 v147, v147, v237, s85
    v_perm_b32 v132, v132, v135, s80
    v_add3_u32 v132, v132, v237, s90
    v_lshl_or_b32 v146, v133, 25, v146
    v_and_b32 v133, 0x003fff80, v133
    v_lshl_or_b32 v147, v134, 25, v147
    v_and_b32 v134, 0x003fff80, v134
    v_lshl_or_b32 v132, v135, 25, v132
    v_and_b32 v135, 0x003fff80, v135
    v_bfe_i32 v253, v136, 24, 4
    v_lshrrev_b32 v186, 1, v137
    v_or_b32 v189, -5, v137
    v_bitop3_b32 v186, v186, v189, 60 bitop3:0x80
    v_lshrrev_b32 v187, 1, v138
    v_or_b32 v190, -5, v138
    v_bitop3_b32 v187, v187, v190, 60 bitop3:0x80
    v_lshrrev_b32 v188, 1, v139
    v_or_b32 v191, -5, v139
    v_bitop3_b32 v188, v188, v191, 60 bitop3:0x80
    v_cmpx_lt_i32 vcc, 0, v253
    ds_add_rtn_u32 v202, v186, v225 offset:36864
    v_cmpx_lt_i32 vcc, 1, v253
    ds_add_rtn_u32 v203, v187, v225 offset:36864
    v_cmpx_lt_i32 vcc, 2, v253
    ds_add_rtn_u32 v204, v188, v225 offset:36864
    s_mov_b64 exec, -1
    s_waitcnt lgkmcnt(6)
    v_min_u32_sdwa v199, v199, v226 dst_sel:WORD_0 dst_unused:UNUSED_PAD src0_sel:DWORD src1_sel:DWORD
    v_min_u32_sdwa v200, v200, v226 dst_sel:WORD_0 dst_unused:UNUSED_PAD src0_sel:DWORD src1_sel:DWORD
    v_min_u32_sdwa v201, v201, v226 dst_sel:WORD_0 dst_unused:UNUSED_PAD src0_sel:DWORD src1_sel:DWORD
    ds_write2st64_b32 v199, v133, v146 offset0:128 offset1:221
    ds_write2st64_b32 v200, v134, v147 offset0:128 offset1:221
    ds_write2st64_b32 v201, v135, v132 offset0:128 offset1:221
    v_perm_b32 v148, v136, v137, s78
    v_add3_u32 v148, v148, v238, s82
    v_perm_b32 v149, v136, v138, s79
    v_add3_u32 v149, v149, v238, s85
    v_perm_b32 v136, v136, v139, s80
    v_add3_u32 v136, v136, v238, s90
    v_lshl_or_b32 v148, v137, 25, v148
    v_and_b32 v137, 0x003fff80, v137
    v_lshl_or_b32 v149, v138, 25, v149
    v_and_b32 v138, 0x003fff80, v138
    v_lshl_or_b32 v136, v139, 25, v136
    v_and_b32 v139, 0x003fff80, v139
    v_bfe_i32 v254, v140, 24, 4
    v_lshrrev_b32 v186, 1, v141
    v_or_b32 v189, -5, v141
    v_bitop3_b32 v186, v186, v189, 60 bitop3:0x80
    v_lshrrev_b32 v187, 1, v142
    v_or_b32 v190, -5, v142
    v_bitop3_b32 v187, v187, v190, 60 bitop3:0x80
    v_lshrrev_b32 v188, 1, v143
    v_or_b32 v191, -5, v143
    v_bitop3_b32 v188, v188, v191, 60 bitop3:0x80
    v_cmpx_lt_i32 vcc, 0, v254
    ds_add_rtn_u32 v205, v186, v225 offset:36864
    v_cmpx_lt_i32 vcc, 1, v254
    ds_add_rtn_u32 v206, v187, v225 offset:36864
    v_cmpx_lt_i32 vcc, 2, v254
    ds_add_rtn_u32 v207, v188, v225 offset:36864
    s_mov_b64 exec, -1
    s_waitcnt lgkmcnt(6)
    v_min_u32_sdwa v202, v202, v226 dst_sel:WORD_0 dst_unused:UNUSED_PAD src0_sel:DWORD src1_sel:DWORD
    v_min_u32_sdwa v203, v203, v226 dst_sel:WORD_0 dst_unused:UNUSED_PAD src0_sel:DWORD src1_sel:DWORD
    v_min_u32_sdwa v204, v204, v226 dst_sel:WORD_0 dst_unused:UNUSED_PAD src0_sel:DWORD src1_sel:DWORD
    ds_write2st64_b32 v202, v137, v148 offset0:128 offset1:221
    ds_write2st64_b32 v203, v138, v149 offset0:128 offset1:221
    ds_write2st64_b32 v204, v139, v136 offset0:128 offset1:221
    v_perm_b32 v150, v140, v141, s78
    v_add3_u32 v150, v150, v239, s82
    v_perm_b32 v151, v140, v142, s79
    v_add3_u32 v151, v151, v239, s85
    v_perm_b32 v140, v140, v143, s80
    v_add3_u32 v140, v140, v239, s90
    v_lshl_or_b32 v150, v141, 25, v150
    v_and_b32 v141, 0x003fff80, v141
    v_lshl_or_b32 v151, v142, 25, v151
    v_and_b32 v142, 0x003fff80, v142
    v_lshl_or_b32 v140, v143, 25, v140
    v_and_b32 v143, 0x003fff80, v143
    s_cmp_ge_u32 s28, 4
    s_cbranch_scc1 K_nomid
    ds_read_b128 v[180:183], v248
    ds_read_b32 v185, v247
    s_waitcnt lgkmcnt(0)
    v_max3_u32 v184, v180, v181, v182
    v_max3_u32 v184, v184, v183, v185
    v_cmp_eq_u32 vcc, -1, v184
    s_nop 0
    s_cbranch_vccnz K_nomid
    v_or_b32 v180, v180, v242
    v_or_b32 v181, v181, v242
    v_or_b32 v182, v182, v242
    v_or_b32 v183, v183, v242
    v_mad_u32_u24 v184, v185, 2, v243
    buffer_load_dwordx4 v[160:163], v180, s[4:7], 0 offen
    buffer_load_dwordx4 v[164:167], v181, s[4:7], 0 offen
    buffer_load_dwordx4 v[168:171], v182, s[4:7], 0 offen
    buffer_load_dwordx4 v[172:175], v183, s[4:7], 0 offen
    buffer_load_dwordx4 v184, s[8:11], 0 offen nt lds
    v_add_u32_sdwa v241, v245, v185 dst_sel:DWORD dst_unused:UNUSED_PAD src0_sel:DWORD src1_sel:BYTE_3
    s_mov_b32 s77, 1
    ds_write_b16 v241, v249
K_nomid:
    s_waitcnt lgkmcnt(3)
    v_min_u32_sdwa v205, v205, v226 dst_sel:WORD_0 dst_unused:UNUSED_PAD src0_sel:DWORD src1_sel:DWORD
    v_min_u32_sdwa v206, v206, v226 dst_sel:WORD_0 dst_unused:UNUSED_PAD src0_sel:DWORD src1_sel:DWORD
    v_min_u32_sdwa v207, v207, v226 dst_sel:WORD_0 dst_unused:UNUSED_PAD src0_sel:DWORD src1_sel:DWORD
    ds_write2st64_b32 v205, v141, v150 offset0:128 offset1:221
    ds_write2st64_b32 v206, v142, v151 offset0:128 offset1:221
    ds_write2st64_b32 v207, v143, v140 offset0:128 offset1:221
K_placed:
    v_bitop3_b32 v208, v251, v252, v253 bitop3:0xfe
    v_or_b32 v208, v208, v254
    v_cmp_lt_u32 vcc, 3, v208
    s_nop 0
    s_cbranch_vccnz K_flag
K_cntdone:
    s_lshl3_add_u32 s3, s77, s28
    s_cmp_ge_u32 s3, 4
    s_cbranch_scc1 K_noeg
    s_mov_b32 s3, 6
K_eg:
    ds_read_b128 v[180:183], v248
    ds_read_b32 v185, v247
    s_sub_u32 s3, s3, 1
    s_cbranch_scc1 K_noeg
    s_waitcnt lgkmcnt(0)
    v_max3_u32 v184, v180, v181, v182
    v_max3_u32 v184, v184, v183, v185
    v_cmp_eq_u32 vcc, -1, v184
    s_nop 0
    s_cbranch_vccnz K_eg
K_egok:
    v_or_b32 v180, v180, v242
    v_or_b32 v181, v181, v242
    v_or_b32 v182, v182, v242
    v_or_b32 v183, v183, v242
    v_mad_u32_u24 v184, v185, 2, v243
    buffer_load_dwordx4 v[160:163], v180, s[4:7], 0 offen
    buffer_load_dwordx4 v[164:167], v181, s[4:7], 0 offen
    buffer_load_dwordx4 v[168:171], v182, s[4:7], 0 offen
    buffer_load_dwordx4 v[172:175], v183, s[4:7], 0 offen
    buffer_load_dwordx4 v184, s[8:11], 0 offen nt lds
    v_add_u32_sdwa v241, v245, v185 dst_sel:DWORD dst_unused:UNUSED_PAD src0_sel:DWORD src1_sel:BYTE_3
    s_mov_b32 s77, 1
    ds_write_b16 v241, v249
K_noeg:
    s_setprio 0
    s_cmp_ge_u32 s28, 4
    s_cbranch_scc1 K_noeb
    v_permlane32_swap_b32 v64, v66
    v_permlane32_swap_b32 v65, v67
    v_permlane32_swap_b32 v68, v70
    v_permlane32_swap_b32 v69, v71
    v_permlane32_swap_b32 v72, v74
    v_permlane32_swap_b32 v73, v75
    v_permlane32_swap_b32 v76, v78
    v_permlane32_swap_b32 v77, v79
    v_permlane32_swap_b32 v80, v82
    v_permlane32_swap_b32 v81, v83
    v_permlane32_swap_b32 v84, v86
    v_permlane32_swap_b32 v85, v87
    v_permlane32_swap_b32 v88, v90
    v_permlane32_swap_b32 v89, v91
    v_permlane32_swap_b32 v92, v94
    v_permlane32_swap_b32 v93, v95
    v_mov_b64 v[96:97], 0
    v_mov_b64 v[98:99], 0
    v_mov_b64 v[100:101], 0
    v_mov_b64 v[102:103], 0
    v_mov_b64 v[104:105], 0
    v_mov_b64 v[106:107], 0
    v_mov_b64 v[108:109], 0
    v_mov_b64 v[110:111], 0
    v_mov_b64 v[112:113], 0
    v_mov_b64 v[114:115], 0
    v_mov_b64 v[116:117], 0
    v_mov_b64 v[118:119], 0
    v_mov_b64 v[120:121], 0
    v_mov_b64 v[122:123], 0
    v_mov_b64 v[124:125], 0
    v_mov_b64 v[126:127], 0
    s_and_b32 s38, s28, 3
    v_lshrrev_b32 v214, 3, v255
    s_lshl_b32 s3, s28, 2
    v_and_b32 v251, 3, v255
    s_lshr_b32 s39, 0x1325467, s3
    v_mul_f32 v214, 0x43840000, v214
    s_and_b32 s39, s39, 7
    v_and_b32 v252, 4, v255
    s_mov_b32 s58, 0xf000f000
    v_fmamk_f32 v214, v251, 0x41800000, v214
    s_mov_b32 s59, s58
    v_and_b32 v215, 96, v242
    s_cmp_lt_u32 s38, 2
    v_fmamk_f32 v214, v252, 0x42000000, v214
    s_mov_b32 s56, 0xf000f0
    v_fmamk_f32 v251, v251, 0x43880000, v215
    s_cselect_b32 s56, 0xe000e0, s56
    v_and_b32 v252, 8, v255
    s_mov_b32 s57, s56
    v_fmamk_f32 v251, v252, 0x43080000, v251
    s_sub_u32 s3, m0, 1536
    v_add_u32 v219, s3, v251
    s_xor_b32 s3, s28, 4
    v_mov_b32 v216, s3
    s_max_u32 s3, s39, s28
    v_mov_b32 v217, s38
    s_mov_b64 exec, s[58:59]
    v_mov_b32 v216, s39
    v_mov_b32 v217, s3
    s_mov_b64 exec, -1
    v_fmamk_f32 v216, v216, 0x45210000, v251
    v_mul_f32 v217, 4.0, v217
    v_cmp_gt_u32 s[86:87], s18, v228
    v_mov_b32 v213, 1
    s_or_b64 s[38:39], s[56:57], s[58:59]
    v_mov_b32 v218, 0
    s_andn2_b64 s[86:87], s[86:87], s[38:39]
K_noeb:
    s_waitcnt lgkmcnt(0)
    s_barrier
    ds_read_b32 v128, v240 offset:36864
    s_cmp_lg_u32 s77, 0
    s_cbranch_scc1 K_nolg
    s_setprio 1
    ds_read_b128 v[180:183], v248
    ds_read_b32 v185, v247
    s_waitcnt lgkmcnt(0)
    v_max3_u32 v184, v180, v181, v182
    v_max3_u32 v184, v184, v183, v185
    v_cmp_eq_u32 vcc, -1, v184
    s_nop 0
    s_cbranch_vccnz K_nolg
    v_or_b32 v180, v180, v242
    v_or_b32 v181, v181, v242
    v_or_b32 v182, v182, v242
    v_or_b32 v183, v183, v242
    v_mad_u32_u24 v184, v185, 2, v243
    buffer_load_dwordx4 v[160:163], v180, s[4:7], 0 offen
    buffer_load_dwordx4 v[164:167], v181, s[4:7], 0 offen
    buffer_load_dwordx4 v[168:171], v182, s[4:7], 0 offen
    buffer_load_dwordx4 v[172:175], v183, s[4:7], 0 offen
    buffer_load_dwordx4 v184, s[8:11], 0 offen nt lds
    v_add_u32_sdwa v241, v245, v185 dst_sel:DWORD dst_unused:UNUSED_PAD src0_sel:DWORD src1_sel:BYTE_3
    s_mov_b32 s77, 1
    ds_write_b16 v241, v249
K_nolg:
    s_setprio 0
    v_mul_f32 v140, 4.0, v255
    s_sub_u32 s3, s37, s93
    v_mov_b32 v152, 4194176
    v_mov_b32 v153, s3
    v_add_u32 v141, 256, v140
    v_add_u32 v142, 512, v140
    v_mov_b32 v147, s55
    v_mov_b32 v148, s93
    v_mov_b64 v[154:155], v[152:153]
    v_mov_b64 v[156:157], v[152:153]
    v_mov_b64 v[158:159], v[152:153]
    s_mov_b32 s39, 0x8010000
    s_waitcnt lgkmcnt(0)
    v_sub_u32_sdwa v129, v128, v229 dst_sel:DWORD dst_unused:UNUSED_PAD src0_sel:WORD_1 src1_sel:WORD_1
    v_cmp_le_u32 s[40:41], s39, v128
    s_nop 0
    v_add_u32_dpp v130, v129, v129 row_shr:1 row_mask:0xf bank_mask:0xf bound_ctrl:0
    s_nop 1
    v_add_u32_dpp v130, v130, v130 row_shr:2 row_mask:0xf bank_mask:0xf bound_ctrl:0
    s_nop 1
    v_add_u32_dpp v130, v130, v130 row_shr:4 row_mask:0xf bank_mask:0xf bound_ctrl:0
    s_nop 1
    v_add_u32_dpp v130, v130, v130 row_shr:8 row_mask:0xf bank_mask:0xf bound_ctrl:0
    s_nop 0
    v_readlane_b32 s85, v130, 15
    s_nop 0
    s_cmp_gt_u32 s85, 12800
    s_cselect_b32 s64, 60, 124
    s_cselect_b32 s65, 5, 6
    s_cselect_b32 s66, 3, 1
    s_add_u32 s3, s85, s64
    s_lshr_b32 s3, s3, s65
    s_not_b32 s67, s66
    s_or_b32 s3, s3, 1
    v_mul_u32_u24_sdwa v131, s3, v229 dst_sel:DWORD dst_unused:UNUSED_PAD src0_sel:DWORD src1_sel:BYTE_0
    v_mul_u32_u24_sdwa v132, s3, v229 dst_sel:DWORD dst_unused:UNUSED_PAD src0_sel:DWORD src1_sel:BYTE_1
    v_mov_b32 v229, 0
    v_lshrrev_b32 v131, 3, v131
    v_lshrrev_b32 v132, 3, v132
    v_sad_u32 v132, v132, v131, s66
    v_and_b32 v132, s67, v132
    v_fma_f32 v131, v131, 2.0, v132
    v_lshlrev_b32 v131, s65, v131
    v_min_u32 v131, s85, v131
    v_sub_u32 v131, v131, v130
    v_add_u32 v132, v131, v129
    s_nop 0
    v_max_i32_dpp v133, v131, v131 row_ror:2 row_mask:0xf bank_mask:0xf
    v_min_i32_dpp v134, v132, v132 row_ror:2 row_mask:0xf bank_mask:0xf
    s_nop 0
    v_max_i32_dpp v133, v133, v133 row_ror:4 row_mask:0xf bank_mask:0xf
    v_min_i32_dpp v134, v134, v134 row_ror:4 row_mask:0xf bank_mask:0xf
    s_nop 0
    v_max_i32_dpp v133, v133, v133 row_ror:8 row_mask:0xf bank_mask:0xf
    v_min_i32_dpp v134, v134, v134 row_ror:8 row_mask:0xf bank_mask:0xf
    v_add_u32 v133, v133, v134
    v_ashrrev_i32 v133, 1, v133
    v_and_b32 v133, -4, v133
    v_sub_u32 v132, v132, v133
    v_med3_i32 v135, v132, 0, v129
    v_sub_u32 v136, v129, v135
    v_readlane_b32 s79, v129, s60
    v_mov_b32_dpp v137, v135 row_ror:15 row_mask:0xf bank_mask:0xf
    v_readlane_b32 s89, v135, s61
    s_nop 0
    v_add_u32_dpp v137, v136, v137 row_ror:1 row_mask:0xf bank_mask:0xf
    v_readlane_b32 s82, v136, s61
    s_movk_i32 s3, 124
    v_add3_u32 v138, v137, v129, s3
    s_add_u32 s88, s79, s54
    v_and_b32 v138, 0xffffff80, v138
    s_add_u32 s89, s89, s62
    v_sub_u32 v139, v138, v129
    s_sub_u32 s3, s63, s82
    v_readlane_b32 s80, v137, s60
    v_add_u32 v144, s89, v140
    v_add_u32 v145, s3, v140
    v_cmp_gt_u32 s[42:43], s82, v140
    v_cmp_gt_u32 s[44:45], s82, v141
    v_cmp_gt_u32 s[46:47], s82, v142
    v_add_u32 v146, s88, v140
    v_cmp_lt_u32 vcc, 2048, v138
    v_cndmask_b32_e64 v196, v145, v144, s[42:43]
    v_cndmask_b32_e64 v197, v145, v144, s[44:45]
    v_cndmask_b32_e64 v198, v145, v144, s[46:47]
    s_mov_b32 s3, vcc_lo
    v_cmp_lt_u32 vcc, 1024, v139
    v_readlane_b32 s76, v138, s60
    s_or_b32 s3, s3, vcc_lo
    s_and_b32 s3, s3, 0x5555
    s_or_b32 s3, s3, s40
    s_cbranch_scc1 K_slow_init
    s_xor_b32 s3, s60, 2
    v_readlane_b32 s38, v138, s3
    v_cmpx_gt_u32 vcc, s80, v140
    ds_read2st64_b32 v[152:153], v196 offset0:128 offset1:221
    v_cmpx_gt_u32 vcc, s80, v141
    ds_read2st64_b32 v[154:155], v197 offset0:129 offset1:222
    v_cmpx_gt_u32 vcc, s80, v142
    ds_read2st64_b32 v[156:157], v198 offset0:130 offset1:223
    s_mov_b64 exec, -1
    v_cndmask_b32_e64 v200, v148, v147, s[42:43]
    v_cndmask_b32_e64 v201, v148, v147, s[44:45]
    v_cndmask_b32_e64 v202, v148, v147, s[46:47]
    s_max_u32 s3, s76, 256
    s_sub_u32 s79, s3, s79
    s_add_u32 s38, s38, s76
    s_lshr_b32 s76, s76, 7
    s_cmp_gt_u32 s38, 3072
    s_mov_b32 s3, 46037
    s_cselect_b32 s3, 4403, s3
    s_cmp_gt_u32 s85, 12800
    s_cselect_b32 s3, 16, s3
    s_cmp_gt_u32 s38, 3200
    s_cselect_b32 s3, 0, s3
    s_getreg_b32 s38, hwreg(HW_REG_XCC_ID, 0, 4)
    s_lshl3_add_u32 s38, s38, s28
    s_and_b32 s38, s38, 12
    s_lshr_b32 s82, s3, s38
    s_and_b32 s3, s82, 7
    s_sub_i32 s78, s76, s3
    s_add_i32 s78, s78, 1
    s_max_i32 s78, s78, 2
    s_cmp_gt_u32 s79, 768
    s_waitcnt lgkmcnt(2)
    v_add_u32 v153, v153, v200
    v_cmpx_gt_u32 vcc, s79, v140
    ds_write2st64_b32 v146, v152, v153 offset0:128 offset1:221
    s_waitcnt lgkmcnt(2)
    v_add_u32 v155, v155, v201
    v_cmpx_gt_u32 vcc, s79, v141
    ds_write2st64_b32 v146, v154, v155 offset0:129 offset1:222
    s_waitcnt lgkmcnt(2)
    v_add_u32 v157, v157, v202
    v_cmpx_gt_u32 vcc, s79, v142
    ds_write2st64_b32 v146, v156, v157 offset0:130 offset1:223
    s_cbranch_scc1 K_four
K_four_r:
    s_mov_b64 exec, -1
    s_sub_u32 s3, s79, s80
    s_mov_b32 s62, 0
    s_bitcmp1_b32 s3, 6
    s_cbranch_scc1 K_spread
K_spread_r:
    s_cmp_eq_u32 s76, 0
    s_cbranch_scc1 K_none
K_go:
    ds_read_b128 v[236:239], v248 offset:128
    ds_read_b32 v240, v247 offset:128
    s_cmp_lg_u32 s77, 0
    s_cbranch_scc1 K_had
    ds_read_b128 v[180:183], v248
    ds_read_b32 v185, v247
    s_waitcnt lgkmcnt(0)
    v_or_b32 v180, v180, v242
    v_or_b32 v181, v181, v242
    v_or_b32 v182, v182, v242
    v_or_b32 v183, v183, v242
    v_mad_u32_u24 v184, v185, 2, v243
    buffer_load_dwordx4 v[160:163], v180, s[4:7], 0 offen
    buffer_load_dwordx4 v[164:167], v181, s[4:7], 0 offen
    buffer_load_dwordx4 v[168:171], v182, s[4:7], 0 offen
    buffer_load_dwordx4 v[172:175], v183, s[4:7], 0 offen
    buffer_load_dwordx4 v184, s[8:11], 0 offen nt lds
    v_add_u32_sdwa v241, v245, v185 dst_sel:DWORD dst_unused:UNUSED_PAD src0_sel:DWORD src1_sel:BYTE_3
    s_mov_b32 s77, 1
    ds_write_b16 v241, v249
    s_cmp_lg_u32 s83, 0
    s_cbranch_scc1 K_hadw
K_had:
    s_cmp_lt_u32 s28, 4
    s_cbranch_scc1 K_nosba
    v_permlane32_swap_b32 v64, v66
    v_permlane32_swap_b32 v65, v67
    v_permlane32_swap_b32 v68, v70
    v_permlane32_swap_b32 v69, v71
    v_permlane32_swap_b32 v72, v74
    v_permlane32_swap_b32 v73, v75
    v_permlane32_swap_b32 v76, v78
    v_permlane32_swap_b32 v77, v79
    v_permlane32_swap_b32 v80, v82
    v_permlane32_swap_b32 v81, v83
    v_permlane32_swap_b32 v84, v86
    v_permlane32_swap_b32 v85, v87
    v_permlane32_swap_b32 v88, v90
    v_permlane32_swap_b32 v89, v91
    v_permlane32_swap_b32 v92, v94
    v_permlane32_swap_b32 v93, v95
    v_mov_b64 v[96:97], 0
    v_mov_b64 v[98:99], 0
    v_mov_b64 v[100:101], 0
    v_mov_b64 v[102:103], 0
    v_mov_b64 v[104:105], 0
    v_mov_b64 v[106:107], 0
    v_mov_b64 v[108:109], 0
    v_mov_b64 v[110:111], 0
    v_mov_b64 v[112:113], 0
    v_mov_b64 v[114:115], 0
    v_mov_b64 v[116:117], 0
    v_mov_b64 v[118:119], 0
    v_mov_b64 v[120:121], 0
    v_mov_b64 v[122:123], 0
    v_mov_b64 v[124:125], 0
    v_mov_b64 v[126:127], 0
    s_and_b32 s38, s28, 3
    v_lshrrev_b32 v214, 3, v255
    s_lshl_b32 s3, s28, 2
    v_and_b32 v251, 3, v255
    s_lshr_b32 s39, 0x1325467, s3
    v_mul_f32 v214, 0x43840000, v214
    s_and_b32 s39, s39, 7
    v_and_b32 v252, 4, v255
    s_mov_b32 s58, 0xf000f000
    v_fmamk_f32 v214, v251, 0x41800000, v214
    s_mov_b32 s59, s58
    v_and_b32 v215, 96, v242
    s_cmp_lt_u32 s38, 2
    v_fmamk_f32 v214, v252, 0x42000000, v214
    s_mov_b32 s56, 0xf000f0
    v_fmamk_f32 v251, v251, 0x43880000, v215
    s_cselect_b32 s56, 0xe000e0, s56
    v_and_b32 v252, 8, v255
    s_mov_b32 s57, s56
    v_fmamk_f32 v251, v252, 0x43080000, v251
    s_sub_u32 s3, m0, 1536
    v_add_u32 v219, s3, v251
    s_xor_b32 s3, s28, 4
    v_mov_b32 v216, s3
    s_max_u32 s3, s39, s28
    v_mov_b32 v217, s38
    s_mov_b64 exec, s[58:59]
    v_mov_b32 v216, s39
    v_mov_b32 v217, s3
    s_mov_b64 exec, -1
    v_fmamk_f32 v216, v216, 0x45210000, v251
    v_mul_f32 v217, 4.0, v217
    v_cmp_gt_u32 s[86:87], s18, v228
    v_mov_b32 v213, 1
    s_or_b64 s[38:39], s[56:57], s[58:59]
    v_mov_b32 v218, 0
    s_andn2_b64 s[86:87], s[86:87], s[38:39]
K_nosba:
K_hadw:
    s_cmp_ge_u32 s76, 3
    s_cselect_b32 s80, 128, 0
    s_waitcnt vmcnt(0)
K_w1:
    s_setprio 3
    ds_read_b128 v[196:199], v230
    ds_read_b128 v[200:203], v244
    s_waitcnt lgkmcnt(2)
    s_mov_b64 vcc, s[30:31]
    v_cndmask_b32_dpp v180, v164, v160, vcc quad_perm:[1,0,3,2] row_mask:0xf bank_mask:0xf
    v_or_b32 v236, v236, v242
    v_cndmask_b32_dpp v181, v165, v161, vcc quad_perm:[1,0,3,2] row_mask:0xf bank_mask:0xf
    v_or_b32 v237, v237, v242
    v_cndmask_b32_dpp v182, v166, v162, vcc quad_perm:[1,0,3,2] row_mask:0xf bank_mask:0xf
    v_or_b32 v238, v238, v242
    v_cndmask_b32_dpp v183, v167, v163, vcc quad_perm:[1,0,3,2] row_mask:0xf bank_mask:0xf
    v_or_b32 v239, v239, v242
    s_mov_b64 vcc, s[32:33]
    v_cndmask_b32_dpp v184, v160, v164, vcc quad_perm:[1,0,3,2] row_mask:0xf bank_mask:0xf
    v_mad_u32_u24 v251, v240, 2, v243
    v_cndmask_b32_dpp v185, v161, v165, vcc quad_perm:[1,0,3,2] row_mask:0xf bank_mask:0xf
    v_mov_b32 v220, 1.0
    v_cndmask_b32_dpp v186, v162, v166, vcc quad_perm:[1,0,3,2] row_mask:0xf bank_mask:0xf
    v_mov_b32 v221, 1.0
    v_cndmask_b32_dpp v187, v163, v167, vcc quad_perm:[1,0,3,2] row_mask:0xf bank_mask:0xf
    v_mov_b32 v224, 1.0
    s_mov_b64 vcc, s[30:31]
    v_cndmask_b32_dpp v188, v172, v168, vcc quad_perm:[1,0,3,2] row_mask:0xf bank_mask:0xf
    v_mov_b32 v225, 1.0
    v_cndmask_b32_dpp v189, v173, v169, vcc quad_perm:[1,0,3,2] row_mask:0xf bank_mask:0xf
    v_mov_b32 v209, 0x3f7f4f09
    v_cndmask_b32_dpp v190, v174, v170, vcc quad_perm:[1,0,3,2] row_mask:0xf bank_mask:0xf
    v_mov_b32 v210, 0xffff0000
    v_cndmask_b32_dpp v191, v175, v171, vcc quad_perm:[1,0,3,2] row_mask:0xf bank_mask:0xf
    v_mov_b64 v[204:205], 0
    s_mov_b64 vcc, s[32:33]
    v_cndmask_b32_dpp v192, v168, v172, vcc quad_perm:[1,0,3,2] row_mask:0xf bank_mask:0xf
    v_mov_b64 v[206:207], 0
    v_cndmask_b32_dpp v193, v169, v173, vcc quad_perm:[1,0,3,2] row_mask:0xf bank_mask:0xf
    v_mov_b64 v[148:149], 0
    v_cndmask_b32_dpp v194, v170, v174, vcc quad_perm:[1,0,3,2] row_mask:0xf bank_mask:0xf
    v_mov_b64 v[150:151], 0
    v_cndmask_b32_dpp v195, v171, v175, vcc quad_perm:[1,0,3,2] row_mask:0xf bank_mask:0xf
    v_mov_b64 v[152:153], 0
    s_waitcnt lgkmcnt(0)
    s_cmp_lt_u32 s76, 2
    s_cbranch_scc1 K_nog0
    buffer_load_dwordx4 v[160:163], v236, s[4:7], 0 offen
    buffer_load_dwordx4 v[164:167], v237, s[4:7], 0 offen
    buffer_load_dwordx4 v251, s[8:11], 0 offen nt lds
    buffer_load_dwordx4 v[168:171], v238, s[4:7], 0 offen
    buffer_load_dwordx4 v[172:175], v239, s[4:7], 0 offen
K_nog0:
    v_mfma_f32_16x16x32_bf16 v[128:131], v[180:183], v[0:3], 0
    v_mov_b64 v[154:155], 0
    v_mov_b64 v[156:157], 0
    v_mfma_f32_16x16x32_bf16 v[128:131], v[184:187], v[4:7], v[128:131]
    v_mov_b64 v[158:159], 0
    v_mfma_f32_16x16x32_bf16 v[128:131], v[196:199], v[64:67], v[128:131]
    v_mfma_f32_16x16x32_bf16 v[132:135], v[188:191], v[0:3], 0
    v_mfma_f32_16x16x32_bf16 v[132:135], v[192:195], v[4:7], v[132:135]
    v_mfma_f32_16x16x32_bf16 v[132:135], v[200:203], v[64:67], v[132:135]
    v_lshrrev_b32 v253, 4, v255
    s_mul_i32 s3, s28, 2112
    v_lshl_add_u32 v252, v255, 4, s3
    v_fmamk_f32 v252, v253, 0x41000000, v252
    v_lshlrev_b32 v253, s28, v213
    ds_write_b128 v252, v[176:179] offset:16384
    ds_write_b128 v252, v[232:235] offset:17440
    s_mov_b64 exec, 1
    ds_or_b32 v250, v253 offset:36960
    s_mov_b64 exec, -1
    s_setprio 2
    s_bitcmp1_b32 s82, 3
    s_cbranch_scc1 K_ga
    s_setprio 1
K_ga:
    s_cmp_ge_u32 s76, s78
    s_cbranch_scc1 K_in2
    s_branch K_in1
.p2align 6
    s_endpgm
K_loop:
    s_waitcnt lgkmcnt(6)
    v_mul_f32 v221, v221, v151
    v_add_f32 v224, 1.0, v224
    v_add_f32 v225, 1.0, v225
    v_or_b32 v150, v148, v149
    v_or_b32 v149, v146, v147
    v_or_b32 v148, v144, v145
K_in1:
    v_mfma_f32_16x16x32_bf16 v[136:139], v[196:199], v[68:71], 0
    s_setprio 1
    v_cvt_pk_bf16_f32 v151, v220, v221
    v_or_b32_sdwa v128, s36, v128 dst_sel:DWORD dst_unused:UNUSED_PAD src0_sel:DWORD src1_sel:WORD_1
    v_mfma_f32_16x16x32_bf16 v[136:139], v[180:183], v[8:11], v[136:139]
    v_rcp_f32 v224, v224
    v_mfma_f32_16x16x32_bf16 v[136:139], v[184:187], v[12:15], v[136:139]
    v_rcp_f32 v225, v225
    v_mfma_f32_16x16x32_bf16 v[140:143], v[200:203], v[68:71], 0
    v_exp_f32 v220, -v132
    v_mfma_f32_16x16x32_bf16 v[140:143], v[188:191], v[8:11], v[140:143]
    v_exp_f32 v221, -v133
    v_mfma_f32_16x16x32_bf16 v[140:143], v[192:195], v[12:15], v[140:143]
    v_exp_f32 v222, -v134
    v_mfma_f32_16x16x32_bf16 v[120:123], v[148:151], v[204:207], v[120:123]
    s_setprio 2
    v_exp_f32 v223, -v135
    v_or_b32_sdwa v129, s36, v129 dst_sel:DWORD dst_unused:UNUSED_PAD src0_sel:DWORD src1_sel:WORD_1
    v_or_b32_sdwa v130, s36, v130 dst_sel:DWORD dst_unused:UNUSED_PAD src0_sel:DWORD src1_sel:WORD_1
    v_or_b32_sdwa v131, s36, v131 dst_sel:DWORD dst_unused:UNUSED_PAD src0_sel:DWORD src1_sel:WORD_1
    v_add_u32 v248, s80, v248
    v_add_u32 v247, s80, v247
    v_or_b32_sdwa v136, s36, v136 dst_sel:DWORD dst_unused:UNUSED_PAD src0_sel:DWORD src1_sel:WORD_1
    v_mul_f32 v224, v224, v158
    v_mul_f32 v225, v225, v159
    v_add_f32 v220, 1.0, v220
    s_setprio 0
    ds_read_u16_d16 v128, v128 offset:48383
    ds_read_u16_d16_hi v129, v129 offset:48383
    ds_read_u16_d16 v130, v130 offset:48383
    ds_read_u16_d16_hi v131, v131 offset:48383
    ds_read_u16_d16 v136, v136 offset:48383
    s_waitcnt lgkmcnt(5)
    v_add_f32 v221, 1.0, v221
    v_add_f32 v222, 1.0, v222
    v_add_f32 v223, 1.0, v223
    v_or_b32 v158, v156, v157
    v_or_b32 v157, v154, v155
    v_or_b32 v156, v152, v153
    v_mfma_f32_16x16x32_bf16 v[144:147], v[196:199], v[72:75], 0
    s_setprio 1
    v_cvt_pk_bf16_f32 v159, v224, v225
    v_or_b32_sdwa v137, s36, v137 dst_sel:DWORD dst_unused:UNUSED_PAD src0_sel:DWORD src1_sel:WORD_1
    v_mfma_f32_16x16x32_bf16 v[144:147], v[180:183], v[16:19], v[144:147]
    v_rcp_f32 v220, v220
    v_mfma_f32_16x16x32_bf16 v[144:147], v[184:187], v[20:23], v[144:147]
    v_rcp_f32 v221, v221
    v_mfma_f32_16x16x32_bf16 v[148:151], v[200:203], v[72:75], 0
    v_rcp_f32 v222, v222
    v_mfma_f32_16x16x32_bf16 v[148:151], v[188:191], v[16:19], v[148:151]
    v_rcp_f32_e64 v223, v223
    v_mfma_f32_16x16x32_bf16 v[148:151], v[192:195], v[20:23], v[148:151]
    v_exp_f32 v224, -v141
    v_mfma_f32_16x16x32_bf16 v[124:127], v[156:159], v[204:207], v[124:127]
    s_setprio 2
    v_exp_f32 v225, -v142
    v_exp_f32 v226, -v143
    v_or_b32_sdwa v138, s36, v138 dst_sel:DWORD dst_unused:UNUSED_PAD src0_sel:DWORD src1_sel:WORD_1
    v_or_b32_sdwa v139, s36, v139 dst_sel:DWORD dst_unused:UNUSED_PAD src0_sel:DWORD src1_sel:WORD_1
    v_or_b32_sdwa v140, s36, v140 dst_sel:DWORD dst_unused:UNUSED_PAD src0_sel:DWORD src1_sel:WORD_1
    v_or_b32_sdwa v144, s36, v144 dst_sel:DWORD dst_unused:UNUSED_PAD src0_sel:DWORD src1_sel:WORD_1
    v_mul_f32 v220, v220, v132
    v_mul_f32 v221, v221, v133
    v_mul_f32 v222, v222, v134
    s_setprio 0
    ds_read_b64_tr_b16 v[204:205], v246
    ds_read_b64_tr_b16 v[206:207], v246 offset:48
    ds_read_u16_d16_hi v137, v137 offset:48383
    ds_read_u16_d16 v138, v138 offset:48383
    ds_read_u16_d16_hi v139, v139 offset:48383
    ds_read_u16_d16 v140, v140 offset:48383
    ds_read_u16_d16 v144, v144 offset:48383
    ds_write_b16 v241, v250
    s_waitcnt lgkmcnt(9)
    v_mul_f32 v223, v223, v135
    v_fma_f32 v224, v224, v209, v209
    v_add_f32 v225, 1.0, v225
    v_add_f32 v226, 1.0, v226
    v_or_b32 v133, v130, v131
    v_or_b32 v132, v128, v129
    v_mfma_f32_16x16x32_bf16 v[152:155], v[196:199], v[76:79], 0
    s_setprio 1
    v_cvt_pk_bf16_f32 v135, v222, v223
    v_cvt_pk_bf16_f32 v134, v220, v221
    v_mfma_f32_16x16x32_bf16 v[152:155], v[180:183], v[24:27], v[152:155]
    v_rcp_f32 v224, v224
    v_mfma_f32_16x16x32_bf16 v[152:155], v[184:187], v[28:31], v[152:155]
    v_rcp_f32 v225, v225
    v_mfma_f32_16x16x32_bf16 v[156:159], v[200:203], v[76:79], 0
    v_rcp_f32 v226, v226
    v_mfma_f32_16x16x32_bf16 v[156:159], v[188:191], v[24:27], v[156:159]
    v_exp_f32 v220, -v149
    v_mfma_f32_16x16x32_bf16 v[156:159], v[192:195], v[28:31], v[156:159]
    s_waitcnt lgkmcnt(6)
    v_exp_f32 v221, -v150
    v_mfma_f32_16x16x32_bf16 v[96:99], v[132:135], v[204:207], v[96:99]
    s_setprio 2
    v_exp_f32 v222, -v151
    v_or_b32_sdwa v145, s36, v145 dst_sel:DWORD dst_unused:UNUSED_PAD src0_sel:DWORD src1_sel:WORD_1
    v_or_b32_sdwa v146, s36, v146 dst_sel:DWORD dst_unused:UNUSED_PAD src0_sel:DWORD src1_sel:WORD_1
    v_or_b32_sdwa v147, s36, v147 dst_sel:DWORD dst_unused:UNUSED_PAD src0_sel:DWORD src1_sel:WORD_1
    v_or_b32_sdwa v148, s36, v148 dst_sel:DWORD dst_unused:UNUSED_PAD src0_sel:DWORD src1_sel:WORD_1
    v_add_u32_sdwa v241, v245, v240 dst_sel:DWORD dst_unused:UNUSED_PAD src0_sel:DWORD src1_sel:BYTE_3
    v_or_b32_sdwa v152, s36, v152 dst_sel:DWORD dst_unused:UNUSED_PAD src0_sel:DWORD src1_sel:WORD_1
    v_mul_f32 v141, v224, v141
    v_mul_f32 v225, v225, v142
    v_mul_f32 v226, v226, v143
    s_setprio 0
    ds_read_u16_d16_hi v145, v145 offset:48383
    ds_read_u16_d16 v146, v146 offset:48383
    ds_read_u16_d16_hi v147, v147 offset:48383
    ds_read_u16_d16 v148, v148 offset:48383
    ds_read_u16_d16 v152, v152 offset:48383
    ds_write_b16 v241, v249
    ds_read_b128 v[236:239], v248 offset:128
    ds_read_b32 v240, v247 offset:128
    s_cmp_ge_u32 s76, 4
    s_cselect_b32 s80, 128, 0
    s_waitcnt lgkmcnt(10)
    v_fma_f32 v220, v220, v209, v209
    v_add_f32 v221, 1.0, v221
    v_add_f32 v222, 1.0, v222
    v_bitop3_b32 v142, v141, v210, v140 bitop3:0xea
    v_or_b32 v141, v138, v139
    v_or_b32 v140, v136, v137
    v_mfma_f32_16x16x32_bf16 v[128:131], v[196:199], v[80:83], 0
    s_setprio 1
    v_cvt_pk_bf16_f32 v143, v225, v226
    v_or_b32_sdwa v153, s36, v153 dst_sel:DWORD dst_unused:UNUSED_PAD src0_sel:DWORD src1_sel:WORD_1
    v_mfma_f32_16x16x32_bf16 v[128:131], v[180:183], v[32:35], v[128:131]
    v_rcp_f32 v220, v220
    v_mfma_f32_16x16x32_bf16 v[128:131], v[184:187], v[36:39], v[128:131]
    v_rcp_f32 v221, v221
    v_mfma_f32_16x16x32_bf16 v[132:135], v[200:203], v[80:83], 0
    v_rcp_f32_e64 v222, v222
    v_mfma_f32_16x16x32_bf16 v[132:135], v[188:191], v[32:35], v[132:135]
    v_exp_f32 v224, -v156
    v_mfma_f32_16x16x32_bf16 v[132:135], v[192:195], v[36:39], v[132:135]
    v_exp_f32 v225, -v157
    v_mfma_f32_16x16x32_bf16 v[100:103], v[140:143], v[204:207], v[100:103]
    s_setprio 2
    v_exp_f32 v226, -v158
    v_exp_f32 v227, -v159
    v_or_b32_sdwa v154, s36, v154 dst_sel:DWORD dst_unused:UNUSED_PAD src0_sel:DWORD src1_sel:WORD_1
    v_or_b32_sdwa v155, s36, v155 dst_sel:DWORD dst_unused:UNUSED_PAD src0_sel:DWORD src1_sel:WORD_1
    v_add3_u32 v229, v204, v205, v229
    v_or_b32_sdwa v128, s36, v128 dst_sel:DWORD dst_unused:UNUSED_PAD src0_sel:DWORD src1_sel:WORD_1
    v_mul_f32 v149, v220, v149
    v_mul_f32 v221, v221, v150
    v_mul_f32 v222, v222, v151
    s_setprio 0
    ds_read_u16_d16_hi v153, v153 offset:48383
    ds_read_u16_d16 v154, v154 offset:48383
    ds_read_u16_d16_hi v155, v155 offset:48383
    ds_read_u16_d16 v128, v128 offset:48383
    s_waitcnt lgkmcnt(8)
    v_add_f32 v224, 1.0, v224
    v_add_f32 v225, 1.0, v225
    v_add_f32 v226, 1.0, v226
    v_add_f32 v227, 1.0, v227
    v_bitop3_b32 v150, v149, v210, v148 bitop3:0xea
    v_or_b32 v149, v146, v147
    v_or_b32 v148, v144, v145
    v_mfma_f32_16x16x32_bf16 v[136:139], v[196:199], v[84:87], 0
    s_setprio 1
    v_cvt_pk_bf16_f32 v151, v221, v222
    v_or_b32_sdwa v129, s36, v129 dst_sel:DWORD dst_unused:UNUSED_PAD src0_sel:DWORD src1_sel:WORD_1
    v_mfma_f32_16x16x32_bf16 v[136:139], v[180:183], v[40:43], v[136:139]
    v_rcp_f32 v224, v224
    v_mfma_f32_16x16x32_bf16 v[136:139], v[184:187], v[44:47], v[136:139]
    v_rcp_f32 v225, v225
    v_mfma_f32_16x16x32_bf16 v[140:143], v[200:203], v[84:87], 0
    v_rcp_f32 v226, v226
    v_mfma_f32_16x16x32_bf16 v[140:143], v[188:191], v[40:43], v[140:143]
    v_rcp_f32_e64 v227, v227
    v_mfma_f32_16x16x32_bf16 v[140:143], v[192:195], v[44:47], v[140:143]
    v_exp_f32 v220, -v131
    v_mfma_f32_16x16x32_bf16 v[104:107], v[148:151], v[204:207], v[104:107]
    s_setprio 2
    v_exp_f32 v221, -v133
    v_exp_f32 v222, -v135
    v_or_b32_sdwa v130, s36, v130 dst_sel:DWORD dst_unused:UNUSED_PAD src0_sel:DWORD src1_sel:WORD_1
    v_or_b32_sdwa v132, s36, v132 dst_sel:DWORD dst_unused:UNUSED_PAD src0_sel:DWORD src1_sel:WORD_1
    v_or_b32_sdwa v134, s36, v134 dst_sel:DWORD dst_unused:UNUSED_PAD src0_sel:DWORD src1_sel:WORD_1
    v_add3_u32 v229, v206, v207, v229
    v_mul_f32 v224, v224, v156
    v_mul_f32 v225, v225, v157
    v_mul_f32 v226, v226, v158
    s_setprio 0
    ds_read_u16_d16_hi v129, v129 offset:48383
    ds_read_u16_d16 v130, v130 offset:48383
    ds_read_u16_d16 v132, v132 offset:48383
    ds_read_u16_d16 v134, v134 offset:48383
    s_cmp_ge_u32 s76, 3
    s_cselect_b32 s6, 3200000, 0
    s_cselect_b32 s10, 25600000, 0
    s_waitcnt lgkmcnt(8)
    s_waitcnt lgkmcnt(5)
    v_mul_f32 v227, v227, v159
    v_fma_f32 v220, v220, v209, v209
    v_fma_f32 v221, v221, v209, v209
    v_fma_f32 v222, v222, v209, v209
    v_or_b32 v236, v236, v242
    v_or_b32 v237, v237, v242
    v_or_b32 v157, v154, v155
    v_or_b32 v156, v152, v153
    v_mfma_f32_16x16x32_bf16 v[144:147], v[196:199], v[88:91], 0
    s_setprio 1
    v_cvt_pk_bf16_f32 v159, v226, v227
    v_cvt_pk_bf16_f32 v158, v224, v225
    v_mfma_f32_16x16x32_bf16 v[144:147], v[180:183], v[48:51], v[144:147]
    v_rcp_f32 v220, v220
    v_mfma_f32_16x16x32_bf16 v[144:147], v[184:187], v[52:55], v[144:147]
    v_rcp_f32 v221, v221
    v_mfma_f32_16x16x32_bf16 v[148:151], v[200:203], v[88:91], 0
    v_rcp_f32_e64 v222, v222
    v_mfma_f32_16x16x32_bf16 v[148:151], v[188:191], v[48:51], v[148:151]
    v_exp_f32 v224, -v141
    v_mfma_f32_16x16x32_bf16 v[148:151], v[192:195], v[52:55], v[148:151]
    v_exp_f32 v225, -v143
    v_mfma_f32_16x16x32_bf16 v[108:111], v[156:159], v[204:207], v[108:111]
    s_setprio 2
    v_or_b32_sdwa v136, s36, v136 dst_sel:DWORD dst_unused:UNUSED_PAD src0_sel:DWORD src1_sel:WORD_1
    v_or_b32_sdwa v137, s36, v137 dst_sel:DWORD dst_unused:UNUSED_PAD src0_sel:DWORD src1_sel:WORD_1
    v_or_b32_sdwa v138, s36, v138 dst_sel:DWORD dst_unused:UNUSED_PAD src0_sel:DWORD src1_sel:WORD_1
    v_or_b32_sdwa v139, s36, v139 dst_sel:DWORD dst_unused:UNUSED_PAD src0_sel:DWORD src1_sel:WORD_1
    v_or_b32_sdwa v140, s36, v140 dst_sel:DWORD dst_unused:UNUSED_PAD src0_sel:DWORD src1_sel:WORD_1
    v_or_b32_sdwa v142, s36, v142 dst_sel:DWORD dst_unused:UNUSED_PAD src0_sel:DWORD src1_sel:WORD_1
    v_or_b32_sdwa v144, s36, v144 dst_sel:DWORD dst_unused:UNUSED_PAD src0_sel:DWORD src1_sel:WORD_1
    v_mul_f32 v131, v220, v131
    v_mul_f32 v133, v221, v133
    v_mul_f32 v135, v222, v135
    v_fma_f32 v224, v224, v209, v209
    s_setprio 0
    ds_read_u16_d16 v136, v136 offset:48383
    ds_read_u16_d16_hi v137, v137 offset:48383
    ds_read_u16_d16 v138, v138 offset:48383
    ds_read_u16_d16_hi v139, v139 offset:48383
    ds_read_u16_d16 v140, v140 offset:48383
    ds_read_u16_d16 v142, v142 offset:48383
    ds_read_u16_d16 v144, v144 offset:48383
    s_mov_b64 vcc, s[30:31]
    s_cmp_eq_u32 s76, 1
    s_cbranch_scc1 K_drain
    s_waitcnt lgkmcnt(7)
    v_fma_f32 v225, v225, v209, v209
    v_or_b32 v238, v238, v242
    v_or_b32 v239, v239, v242
    v_bitop3_b32 v135, v135, v210, v134 bitop3:0xea
    v_bitop3_b32 v134, v133, v210, v132 bitop3:0xea
    v_bitop3_b32 v133, v131, v210, v130 bitop3:0xea
    v_or_b32 v132, v128, v129
    v_mfma_f32_16x16x32_bf16 v[152:155], v[180:183], v[56:59], 0
    s_setprio 1
    v_rcp_f32 v224, v224
    v_mfma_f32_16x16x32_bf16 v[152:155], v[184:187], v[60:63], v[152:155]
    v_rcp_f32_e64 v225, v225
    v_mfma_f32_16x16x32_bf16 v[152:155], v[196:199], v[92:95], v[152:155]
    s_waitcnt vmcnt(3)
    v_cndmask_b32_dpp v180, v164, v160, vcc quad_perm:[1,0,3,2] row_mask:0xf bank_mask:0xf
    v_cndmask_b32_dpp v181, v165, v161, vcc quad_perm:[1,0,3,2] row_mask:0xf bank_mask:0xf
    v_mfma_f32_16x16x32_bf16 v[156:159], v[188:191], v[56:59], 0
    v_cndmask_b32_dpp v182, v166, v162, vcc quad_perm:[1,0,3,2] row_mask:0xf bank_mask:0xf
    v_cndmask_b32_dpp v183, v167, v163, vcc quad_perm:[1,0,3,2] row_mask:0xf bank_mask:0xf
    v_mfma_f32_16x16x32_bf16 v[156:159], v[192:195], v[60:63], v[156:159]
    s_mov_b64 vcc, s[32:33]
    v_cndmask_b32_dpp v184, v160, v164, vcc quad_perm:[1,0,3,2] row_mask:0xf bank_mask:0xf
    v_cndmask_b32_dpp v185, v161, v165, vcc quad_perm:[1,0,3,2] row_mask:0xf bank_mask:0xf
    v_mfma_f32_16x16x32_bf16 v[156:159], v[200:203], v[92:95], v[156:159]
    v_cndmask_b32_dpp v186, v162, v166, vcc quad_perm:[1,0,3,2] row_mask:0xf bank_mask:0xf
    v_cndmask_b32_dpp v187, v163, v167, vcc quad_perm:[1,0,3,2] row_mask:0xf bank_mask:0xf
    v_mfma_f32_16x16x32_bf16 v[112:115], v[132:135], v[204:207], v[112:115]
    s_setprio 2
    v_exp_f32 v220, -v150
    v_exp_f32 v221, -v151
    v_or_b32_sdwa v145, s36, v145 dst_sel:DWORD dst_unused:UNUSED_PAD src0_sel:DWORD src1_sel:WORD_1
    v_or_b32_sdwa v146, s36, v146 dst_sel:DWORD dst_unused:UNUSED_PAD src0_sel:DWORD src1_sel:WORD_1
    v_or_b32_sdwa v147, s36, v147 dst_sel:DWORD dst_unused:UNUSED_PAD src0_sel:DWORD src1_sel:WORD_1
    v_or_b32_sdwa v148, s36, v148 dst_sel:DWORD dst_unused:UNUSED_PAD src0_sel:DWORD src1_sel:WORD_1
    v_or_b32_sdwa v149, s36, v149 dst_sel:DWORD dst_unused:UNUSED_PAD src0_sel:DWORD src1_sel:WORD_1
    v_mad_u32_u24 v251, v240, 2, v243
    v_mul_f32 v141, v224, v141
    s_setprio 0
    s_waitcnt vmcnt(2)
    ds_read_b128 v[196:199], v230
    ds_read_b128 v[200:203], v244
    ds_read_u16_d16_hi v145, v145 offset:48383
    ds_read_u16_d16 v146, v146 offset:48383
    ds_read_u16_d16_hi v147, v147 offset:48383
    ds_read_u16_d16 v148, v148 offset:48383
    ds_read_u16_d16_hi v149, v149 offset:48383
    buffer_load_dwordx4 v[160:163], v236, s[4:7], 0 offen
    buffer_load_dwordx4 v[164:167], v237, s[4:7], 0 offen
    s_waitcnt lgkmcnt(5)
    buffer_load_dwordx4 v251, s[8:11], 0 offen nt lds
    v_mul_f32 v143, v225, v143
    v_add_f32 v220, 1.0, v220
    v_add_f32 v221, 1.0, v221
    v_bitop3_b32 v143, v143, v210, v142 bitop3:0xea
    v_bitop3_b32 v142, v141, v210, v140 bitop3:0xea
    v_or_b32 v141, v138, v139
    v_or_b32 v140, v136, v137
    v_mfma_f32_16x16x32_bf16 v[128:131], v[180:183], v[0:3], 0
    s_setprio 1
    v_rcp_f32 v220, v220
    v_mfma_f32_16x16x32_bf16 v[128:131], v[184:187], v[4:7], v[128:131]
    s_waitcnt vmcnt(3)
    v_cndmask_b32_dpp v192, v168, v172, vcc quad_perm:[1,0,3,2] row_mask:0xf bank_mask:0xf
    v_cndmask_b32_dpp v193, v169, v173, vcc quad_perm:[1,0,3,2] row_mask:0xf bank_mask:0xf
    v_mfma_f32_16x16x32_bf16 v[128:131], v[196:199], v[64:67], v[128:131]
    v_cndmask_b32_dpp v194, v170, v174, vcc quad_perm:[1,0,3,2] row_mask:0xf bank_mask:0xf
    v_cndmask_b32_dpp v195, v171, v175, vcc quad_perm:[1,0,3,2] row_mask:0xf bank_mask:0xf
    v_mfma_f32_16x16x32_bf16 v[132:135], v[200:203], v[64:67], 0
    s_mov_b64 vcc, s[30:31]
    v_cndmask_b32_dpp v188, v172, v168, vcc quad_perm:[1,0,3,2] row_mask:0xf bank_mask:0xf
    v_cndmask_b32_dpp v189, v173, v169, vcc quad_perm:[1,0,3,2] row_mask:0xf bank_mask:0xf
    v_mfma_f32_16x16x32_bf16 v[132:135], v[192:195], v[4:7], v[132:135]
    v_cndmask_b32_dpp v190, v174, v170, vcc quad_perm:[1,0,3,2] row_mask:0xf bank_mask:0xf
    v_cndmask_b32_dpp v191, v175, v171, vcc quad_perm:[1,0,3,2] row_mask:0xf bank_mask:0xf
    v_mfma_f32_16x16x32_bf16 v[116:119], v[140:143], v[204:207], v[116:119]
    v_rcp_f32_e64 v221, v221
    v_mfma_f32_16x16x32_bf16 v[132:135], v[188:191], v[0:3], v[132:135]
    s_setprio 2
    v_exp_f32 v224, -v158
    v_exp_f32 v225, -v159
    v_or_b32_sdwa v152, s36, v152 dst_sel:DWORD dst_unused:UNUSED_PAD src0_sel:DWORD src1_sel:WORD_1
    v_or_b32_sdwa v153, s36, v153 dst_sel:DWORD dst_unused:UNUSED_PAD src0_sel:DWORD src1_sel:WORD_1
    v_or_b32_sdwa v154, s36, v154 dst_sel:DWORD dst_unused:UNUSED_PAD src0_sel:DWORD src1_sel:WORD_1
    v_or_b32_sdwa v155, s36, v155 dst_sel:DWORD dst_unused:UNUSED_PAD src0_sel:DWORD src1_sel:WORD_1
    v_or_b32_sdwa v156, s36, v156 dst_sel:DWORD dst_unused:UNUSED_PAD src0_sel:DWORD src1_sel:WORD_1
    v_or_b32_sdwa v157, s36, v157 dst_sel:DWORD dst_unused:UNUSED_PAD src0_sel:DWORD src1_sel:WORD_1
    v_mul_f32 v220, v220, v150
    s_setprio 0
    ds_read_u16_d16 v152, v152 offset:48383
    ds_read_u16_d16_hi v153, v153 offset:48383
    ds_read_u16_d16 v154, v154 offset:48383
    ds_read_u16_d16_hi v155, v155 offset:48383
    ds_read_u16_d16 v156, v156 offset:48383
    ds_read_u16_d16_hi v157, v157 offset:48383
    buffer_load_dwordx4 v[168:171], v238, s[4:7], 0 offen
    buffer_load_dwordx4 v[172:175], v239, s[4:7], 0 offen
    s_sub_u32 s76, s76, 1
    s_cmp_eq_u32 s76, s62
    s_cbranch_scc1 K_half
    s_branch K_loop
K_loopa:
    s_waitcnt lgkmcnt(6)
    v_mul_f32 v221, v221, v151
    v_add_f32 v224, 1.0, v224
    v_add_f32 v225, 1.0, v225
    v_or_b32 v150, v148, v149
    v_or_b32 v149, v146, v147
    v_or_b32 v148, v144, v145
K_in2:
    v_mfma_f32_16x16x32_bf16 v[136:139], v[196:199], v[68:71], 0
    v_cvt_pk_bf16_f32 v151, v220, v221
    v_or_b32_sdwa v128, s36, v128 dst_sel:DWORD dst_unused:UNUSED_PAD src0_sel:DWORD src1_sel:WORD_1
    v_mfma_f32_16x16x32_bf16 v[136:139], v[180:183], v[8:11], v[136:139]
    v_rcp_f32 v224, v224
    v_mfma_f32_16x16x32_bf16 v[136:139], v[184:187], v[12:15], v[136:139]
    v_rcp_f32 v225, v225
    v_mfma_f32_16x16x32_bf16 v[140:143], v[200:203], v[68:71], 0
    v_or_b32_sdwa v129, s36, v129 dst_sel:DWORD dst_unused:UNUSED_PAD src0_sel:DWORD src1_sel:WORD_1
    v_or_b32_sdwa v130, s36, v130 dst_sel:DWORD dst_unused:UNUSED_PAD src0_sel:DWORD src1_sel:WORD_1
    v_mfma_f32_16x16x32_bf16 v[140:143], v[188:191], v[8:11], v[140:143]
    v_or_b32_sdwa v131, s36, v131 dst_sel:DWORD dst_unused:UNUSED_PAD src0_sel:DWORD src1_sel:WORD_1
    v_or_b32_sdwa v132, s36, v132 dst_sel:DWORD dst_unused:UNUSED_PAD src0_sel:DWORD src1_sel:WORD_1
    v_mfma_f32_16x16x32_bf16 v[140:143], v[192:195], v[12:15], v[140:143]
    v_or_b32_sdwa v133, s36, v133 dst_sel:DWORD dst_unused:UNUSED_PAD src0_sel:DWORD src1_sel:WORD_1
    v_or_b32_sdwa v134, s36, v134 dst_sel:DWORD dst_unused:UNUSED_PAD src0_sel:DWORD src1_sel:WORD_1
    v_mfma_f32_16x16x32_bf16 v[120:123], v[148:151], v[204:207], v[120:123]
    v_or_b32_sdwa v135, s36, v135 dst_sel:DWORD dst_unused:UNUSED_PAD src0_sel:DWORD src1_sel:WORD_1
    v_add_u32 v248, s80, v248
    v_add_u32 v247, s80, v247
    v_or_b32_sdwa v136, s36, v136 dst_sel:DWORD dst_unused:UNUSED_PAD src0_sel:DWORD src1_sel:WORD_1
    v_mul_f32 v224, v224, v158
    v_mul_f32 v225, v225, v159
    ds_read_u16_d16 v128, v128 offset:48383
    ds_read_u16_d16_hi v129, v129 offset:48383
    ds_read_u16_d16 v130, v130 offset:48383
    ds_read_u16_d16_hi v131, v131 offset:48383
    ds_read_u16_d16 v132, v132 offset:48383
    ds_read_u16_d16_hi v133, v133 offset:48383
    ds_read_u16_d16 v134, v134 offset:48383
    ds_read_u16_d16_hi v135, v135 offset:48383
    ds_read_u16_d16 v136, v136 offset:48383
    s_waitcnt lgkmcnt(9)
    v_or_b32 v158, v156, v157
    v_or_b32 v157, v154, v155
    v_or_b32 v156, v152, v153
    v_mfma_f32_16x16x32_bf16 v[144:147], v[196:199], v[72:75], 0
    v_cvt_pk_bf16_f32 v159, v224, v225
    v_or_b32_sdwa v137, s36, v137 dst_sel:DWORD dst_unused:UNUSED_PAD src0_sel:DWORD src1_sel:WORD_1
    v_mfma_f32_16x16x32_bf16 v[144:147], v[180:183], v[16:19], v[144:147]
    v_or_b32_sdwa v138, s36, v138 dst_sel:DWORD dst_unused:UNUSED_PAD src0_sel:DWORD src1_sel:WORD_1
    v_or_b32_sdwa v139, s36, v139 dst_sel:DWORD dst_unused:UNUSED_PAD src0_sel:DWORD src1_sel:WORD_1
    v_mfma_f32_16x16x32_bf16 v[144:147], v[184:187], v[20:23], v[144:147]
    v_or_b32_sdwa v140, s36, v140 dst_sel:DWORD dst_unused:UNUSED_PAD src0_sel:DWORD src1_sel:WORD_1
    v_or_b32_sdwa v141, s36, v141 dst_sel:DWORD dst_unused:UNUSED_PAD src0_sel:DWORD src1_sel:WORD_1
    v_mfma_f32_16x16x32_bf16 v[148:151], v[200:203], v[72:75], 0
    v_or_b32_sdwa v142, s36, v142 dst_sel:DWORD dst_unused:UNUSED_PAD src0_sel:DWORD src1_sel:WORD_1
    v_or_b32_sdwa v143, s36, v143 dst_sel:DWORD dst_unused:UNUSED_PAD src0_sel:DWORD src1_sel:WORD_1
    v_mfma_f32_16x16x32_bf16 v[148:151], v[188:191], v[16:19], v[148:151]
    v_mfma_f32_16x16x32_bf16 v[148:151], v[192:195], v[20:23], v[148:151]
    v_mfma_f32_16x16x32_bf16 v[124:127], v[156:159], v[204:207], v[124:127]
    v_or_b32_sdwa v144, s36, v144 dst_sel:DWORD dst_unused:UNUSED_PAD src0_sel:DWORD src1_sel:WORD_1
    s_waitcnt lgkmcnt(1)
    v_or_b32 v135, v134, v135
    v_or_b32 v134, v132, v133
    ds_read_b64_tr_b16 v[204:205], v246
    ds_read_b64_tr_b16 v[206:207], v246 offset:48
    ds_read_u16_d16_hi v137, v137 offset:48383
    ds_read_u16_d16 v138, v138 offset:48383
    ds_read_u16_d16_hi v139, v139 offset:48383
    ds_read_u16_d16 v140, v140 offset:48383
    ds_read_u16_d16_hi v141, v141 offset:48383
    ds_read_u16_d16 v142, v142 offset:48383
    ds_read_u16_d16_hi v143, v143 offset:48383
    ds_read_u16_d16 v144, v144 offset:48383
    ds_write_b16 v241, v250
    v_or_b32 v133, v130, v131
    v_or_b32 v132, v128, v129
    v_mfma_f32_16x16x32_bf16 v[152:155], v[196:199], v[76:79], 0
    v_or_b32_sdwa v145, s36, v145 dst_sel:DWORD dst_unused:UNUSED_PAD src0_sel:DWORD src1_sel:WORD_1
    v_or_b32_sdwa v146, s36, v146 dst_sel:DWORD dst_unused:UNUSED_PAD src0_sel:DWORD src1_sel:WORD_1
    v_mfma_f32_16x16x32_bf16 v[152:155], v[180:183], v[24:27], v[152:155]
    v_or_b32_sdwa v147, s36, v147 dst_sel:DWORD dst_unused:UNUSED_PAD src0_sel:DWORD src1_sel:WORD_1
    v_or_b32_sdwa v148, s36, v148 dst_sel:DWORD dst_unused:UNUSED_PAD src0_sel:DWORD src1_sel:WORD_1
    v_mfma_f32_16x16x32_bf16 v[152:155], v[184:187], v[28:31], v[152:155]
    v_or_b32_sdwa v149, s36, v149 dst_sel:DWORD dst_unused:UNUSED_PAD src0_sel:DWORD src1_sel:WORD_1
    v_or_b32_sdwa v150, s36, v150 dst_sel:DWORD dst_unused:UNUSED_PAD src0_sel:DWORD src1_sel:WORD_1
    v_mfma_f32_16x16x32_bf16 v[156:159], v[200:203], v[76:79], 0
    v_or_b32_sdwa v151, s36, v151 dst_sel:DWORD dst_unused:UNUSED_PAD src0_sel:DWORD src1_sel:WORD_1
    v_add_u32_sdwa v241, v245, v240 dst_sel:DWORD dst_unused:UNUSED_PAD src0_sel:DWORD src1_sel:BYTE_3
    v_mfma_f32_16x16x32_bf16 v[156:159], v[188:191], v[24:27], v[156:159]
    v_mfma_f32_16x16x32_bf16 v[156:159], v[192:195], v[28:31], v[156:159]
    s_waitcnt lgkmcnt(9)
    v_mfma_f32_16x16x32_bf16 v[96:99], v[132:135], v[204:207], v[96:99]
    v_or_b32_sdwa v152, s36, v152 dst_sel:DWORD dst_unused:UNUSED_PAD src0_sel:DWORD src1_sel:WORD_1
    s_waitcnt lgkmcnt(2)
    v_or_b32 v143, v142, v143
    v_or_b32 v142, v140, v141
    ds_read_u16_d16_hi v145, v145 offset:48383
    ds_read_u16_d16 v146, v146 offset:48383
    ds_read_u16_d16_hi v147, v147 offset:48383
    ds_read_u16_d16 v148, v148 offset:48383
    ds_read_u16_d16_hi v149, v149 offset:48383
    ds_read_u16_d16 v150, v150 offset:48383
    ds_read_u16_d16_hi v151, v151 offset:48383
    ds_read_u16_d16 v152, v152 offset:48383
    ds_write_b16 v241, v249
    ds_read_b128 v[236:239], v248 offset:128
    ds_read_b32 v240, v247 offset:128
    s_cmp_ge_u32 s76, 4
    s_cselect_b32 s80, 128, 0
    v_or_b32 v141, v138, v139
    v_or_b32 v140, v136, v137
    v_mfma_f32_16x16x32_bf16 v[128:131], v[196:199], v[80:83], 0
    v_or_b32_sdwa v153, s36, v153 dst_sel:DWORD dst_unused:UNUSED_PAD src0_sel:DWORD src1_sel:WORD_1
    v_or_b32_sdwa v154, s36, v154 dst_sel:DWORD dst_unused:UNUSED_PAD src0_sel:DWORD src1_sel:WORD_1
    v_mfma_f32_16x16x32_bf16 v[128:131], v[180:183], v[32:35], v[128:131]
    v_or_b32_sdwa v155, s36, v155 dst_sel:DWORD dst_unused:UNUSED_PAD src0_sel:DWORD src1_sel:WORD_1
    v_or_b32_sdwa v156, s36, v156 dst_sel:DWORD dst_unused:UNUSED_PAD src0_sel:DWORD src1_sel:WORD_1
    v_mfma_f32_16x16x32_bf16 v[128:131], v[184:187], v[36:39], v[128:131]
    v_or_b32_sdwa v157, s36, v157 dst_sel:DWORD dst_unused:UNUSED_PAD src0_sel:DWORD src1_sel:WORD_1
    v_or_b32_sdwa v158, s36, v158 dst_sel:DWORD dst_unused:UNUSED_PAD src0_sel:DWORD src1_sel:WORD_1
    v_mfma_f32_16x16x32_bf16 v[132:135], v[200:203], v[80:83], 0
    v_or_b32_sdwa v159, s36, v159 dst_sel:DWORD dst_unused:UNUSED_PAD src0_sel:DWORD src1_sel:WORD_1
    v_add3_u32 v229, v204, v205, v229
    v_mfma_f32_16x16x32_bf16 v[132:135], v[188:191], v[32:35], v[132:135]
    v_mfma_f32_16x16x32_bf16 v[132:135], v[192:195], v[36:39], v[132:135]
    v_mfma_f32_16x16x32_bf16 v[100:103], v[140:143], v[204:207], v[100:103]
    v_or_b32_sdwa v128, s36, v128 dst_sel:DWORD dst_unused:UNUSED_PAD src0_sel:DWORD src1_sel:WORD_1
    s_waitcnt lgkmcnt(4)
    v_or_b32 v151, v150, v151
    v_or_b32 v150, v148, v149
    ds_read_u16_d16_hi v153, v153 offset:48383
    ds_read_u16_d16 v154, v154 offset:48383
    ds_read_u16_d16_hi v155, v155 offset:48383
    ds_read_u16_d16 v156, v156 offset:48383
    ds_read_u16_d16_hi v157, v157 offset:48383
    ds_read_u16_d16 v158, v158 offset:48383
    ds_read_u16_d16_hi v159, v159 offset:48383
    ds_read_u16_d16 v128, v128 offset:48383
    v_or_b32 v149, v146, v147
    v_or_b32 v148, v144, v145
    v_mfma_f32_16x16x32_bf16 v[136:139], v[196:199], v[84:87], 0
    v_or_b32_sdwa v129, s36, v129 dst_sel:DWORD dst_unused:UNUSED_PAD src0_sel:DWORD src1_sel:WORD_1
    v_or_b32_sdwa v130, s36, v130 dst_sel:DWORD dst_unused:UNUSED_PAD src0_sel:DWORD src1_sel:WORD_1
    v_mfma_f32_16x16x32_bf16 v[136:139], v[180:183], v[40:43], v[136:139]
    v_or_b32_sdwa v131, s36, v131 dst_sel:DWORD dst_unused:UNUSED_PAD src0_sel:DWORD src1_sel:WORD_1
    v_or_b32_sdwa v132, s36, v132 dst_sel:DWORD dst_unused:UNUSED_PAD src0_sel:DWORD src1_sel:WORD_1
    v_mfma_f32_16x16x32_bf16 v[136:139], v[184:187], v[44:47], v[136:139]
    v_or_b32_sdwa v133, s36, v133 dst_sel:DWORD dst_unused:UNUSED_PAD src0_sel:DWORD src1_sel:WORD_1
    v_or_b32_sdwa v134, s36, v134 dst_sel:DWORD dst_unused:UNUSED_PAD src0_sel:DWORD src1_sel:WORD_1
    v_mfma_f32_16x16x32_bf16 v[140:143], v[200:203], v[84:87], 0
    v_or_b32_sdwa v135, s36, v135 dst_sel:DWORD dst_unused:UNUSED_PAD src0_sel:DWORD src1_sel:WORD_1
    v_add3_u32 v229, v206, v207, v229
    v_mfma_f32_16x16x32_bf16 v[140:143], v[188:191], v[40:43], v[140:143]
    v_mfma_f32_16x16x32_bf16 v[140:143], v[192:195], v[44:47], v[140:143]
    v_mfma_f32_16x16x32_bf16 v[104:107], v[148:151], v[204:207], v[104:107]
    s_waitcnt lgkmcnt(8)
    v_or_b32 v236, v236, v242
    v_or_b32 v237, v237, v242
    ds_read_u16_d16_hi v129, v129 offset:48383
    ds_read_u16_d16 v130, v130 offset:48383
    ds_read_u16_d16_hi v131, v131 offset:48383
    ds_read_u16_d16 v132, v132 offset:48383
    ds_read_u16_d16_hi v133, v133 offset:48383
    ds_read_u16_d16 v134, v134 offset:48383
    ds_read_u16_d16_hi v135, v135 offset:48383
    s_cmp_ge_u32 s76, 3
    s_cselect_b32 s6, 3200000, 0
    s_cselect_b32 s10, 25600000, 0
    s_waitcnt lgkmcnt(8)
    v_or_b32 v159, v158, v159
    v_or_b32 v158, v156, v157
    v_or_b32 v157, v154, v155
    v_or_b32 v156, v152, v153
    v_mfma_f32_16x16x32_bf16 v[144:147], v[196:199], v[88:91], 0
    v_or_b32_sdwa v136, s36, v136 dst_sel:DWORD dst_unused:UNUSED_PAD src0_sel:DWORD src1_sel:WORD_1
    v_or_b32_sdwa v137, s36, v137 dst_sel:DWORD dst_unused:UNUSED_PAD src0_sel:DWORD src1_sel:WORD_1
    v_mfma_f32_16x16x32_bf16 v[144:147], v[180:183], v[48:51], v[144:147]
    v_or_b32_sdwa v138, s36, v138 dst_sel:DWORD dst_unused:UNUSED_PAD src0_sel:DWORD src1_sel:WORD_1
    v_or_b32_sdwa v139, s36, v139 dst_sel:DWORD dst_unused:UNUSED_PAD src0_sel:DWORD src1_sel:WORD_1
    v_mfma_f32_16x16x32_bf16 v[144:147], v[184:187], v[52:55], v[144:147]
    v_or_b32_sdwa v140, s36, v140 dst_sel:DWORD dst_unused:UNUSED_PAD src0_sel:DWORD src1_sel:WORD_1
    v_or_b32_sdwa v141, s36, v141 dst_sel:DWORD dst_unused:UNUSED_PAD src0_sel:DWORD src1_sel:WORD_1
    v_mfma_f32_16x16x32_bf16 v[148:151], v[200:203], v[88:91], 0
    v_or_b32_sdwa v142, s36, v142 dst_sel:DWORD dst_unused:UNUSED_PAD src0_sel:DWORD src1_sel:WORD_1
    v_or_b32_sdwa v143, s36, v143 dst_sel:DWORD dst_unused:UNUSED_PAD src0_sel:DWORD src1_sel:WORD_1
    v_mfma_f32_16x16x32_bf16 v[148:151], v[188:191], v[48:51], v[148:151]
    v_mfma_f32_16x16x32_bf16 v[148:151], v[192:195], v[52:55], v[148:151]
    v_mfma_f32_16x16x32_bf16 v[108:111], v[156:159], v[204:207], v[108:111]
    v_or_b32_sdwa v144, s36, v144 dst_sel:DWORD dst_unused:UNUSED_PAD src0_sel:DWORD src1_sel:WORD_1
    v_or_b32 v238, v238, v242
    v_or_b32 v239, v239, v242
    ds_read_u16_d16 v136, v136 offset:48383
    ds_read_u16_d16_hi v137, v137 offset:48383
    ds_read_u16_d16 v138, v138 offset:48383
    ds_read_u16_d16_hi v139, v139 offset:48383
    ds_read_u16_d16 v140, v140 offset:48383
    ds_read_u16_d16_hi v141, v141 offset:48383
    ds_read_u16_d16 v142, v142 offset:48383
    ds_read_u16_d16_hi v143, v143 offset:48383
    ds_read_u16_d16 v144, v144 offset:48383
    s_mov_b64 vcc, s[30:31]
    s_waitcnt lgkmcnt(9)
    v_or_b32 v135, v134, v135
    v_or_b32 v134, v132, v133
    v_or_b32 v133, v130, v131
    v_or_b32 v132, v128, v129
    v_mfma_f32_16x16x32_bf16 v[152:155], v[180:183], v[56:59], 0
    v_exp_f32 v220, -v150
    v_mfma_f32_16x16x32_bf16 v[152:155], v[184:187], v[60:63], v[152:155]
    v_exp_f32 v221, -v151
    v_mfma_f32_16x16x32_bf16 v[152:155], v[196:199], v[92:95], v[152:155]
    s_waitcnt vmcnt(3)
    v_cndmask_b32_dpp v180, v164, v160, vcc quad_perm:[1,0,3,2] row_mask:0xf bank_mask:0xf
    v_cndmask_b32_dpp v181, v165, v161, vcc quad_perm:[1,0,3,2] row_mask:0xf bank_mask:0xf
    v_mfma_f32_16x16x32_bf16 v[156:159], v[188:191], v[56:59], 0
    v_cndmask_b32_dpp v182, v166, v162, vcc quad_perm:[1,0,3,2] row_mask:0xf bank_mask:0xf
    v_cndmask_b32_dpp v183, v167, v163, vcc quad_perm:[1,0,3,2] row_mask:0xf bank_mask:0xf
    v_mfma_f32_16x16x32_bf16 v[156:159], v[192:195], v[60:63], v[156:159]
    s_mov_b64 vcc, s[32:33]
    v_cndmask_b32_dpp v184, v160, v164, vcc quad_perm:[1,0,3,2] row_mask:0xf bank_mask:0xf
    v_cndmask_b32_dpp v185, v161, v165, vcc quad_perm:[1,0,3,2] row_mask:0xf bank_mask:0xf
    v_mfma_f32_16x16x32_bf16 v[156:159], v[200:203], v[92:95], v[156:159]
    v_cndmask_b32_dpp v186, v162, v166, vcc quad_perm:[1,0,3,2] row_mask:0xf bank_mask:0xf
    v_cndmask_b32_dpp v187, v163, v167, vcc quad_perm:[1,0,3,2] row_mask:0xf bank_mask:0xf
    v_mfma_f32_16x16x32_bf16 v[112:115], v[132:135], v[204:207], v[112:115]
    v_or_b32_sdwa v145, s36, v145 dst_sel:DWORD dst_unused:UNUSED_PAD src0_sel:DWORD src1_sel:WORD_1
    v_or_b32_sdwa v146, s36, v146 dst_sel:DWORD dst_unused:UNUSED_PAD src0_sel:DWORD src1_sel:WORD_1
    v_or_b32_sdwa v147, s36, v147 dst_sel:DWORD dst_unused:UNUSED_PAD src0_sel:DWORD src1_sel:WORD_1
    v_or_b32_sdwa v148, s36, v148 dst_sel:DWORD dst_unused:UNUSED_PAD src0_sel:DWORD src1_sel:WORD_1
    v_or_b32_sdwa v149, s36, v149 dst_sel:DWORD dst_unused:UNUSED_PAD src0_sel:DWORD src1_sel:WORD_1
    v_mad_u32_u24 v251, v240, 2, v243
    s_waitcnt vmcnt(2)
    ds_read_b128 v[196:199], v230
    ds_read_b128 v[200:203], v244
    ds_read_u16_d16_hi v145, v145 offset:48383
    ds_read_u16_d16 v146, v146 offset:48383
    ds_read_u16_d16_hi v147, v147 offset:48383
    ds_read_u16_d16 v148, v148 offset:48383
    ds_read_u16_d16_hi v149, v149 offset:48383
    buffer_load_dwordx4 v[160:163], v236, s[4:7], 0 offen
    buffer_load_dwordx4 v[164:167], v237, s[4:7], 0 offen
    s_waitcnt lgkmcnt(5)
    buffer_load_dwordx4 v251, s[8:11], 0 offen nt lds
    v_add_f32 v220, 1.0, v220
    v_add_f32 v221, 1.0, v221
    v_or_b32 v143, v142, v143
    v_or_b32 v142, v140, v141
    v_or_b32 v141, v138, v139
    v_or_b32 v140, v136, v137
    v_mfma_f32_16x16x32_bf16 v[128:131], v[180:183], v[0:3], 0
    s_waitcnt vmcnt(3)
    v_cndmask_b32_dpp v192, v168, v172, vcc quad_perm:[1,0,3,2] row_mask:0xf bank_mask:0xf
    v_cndmask_b32_dpp v193, v169, v173, vcc quad_perm:[1,0,3,2] row_mask:0xf bank_mask:0xf
    v_mfma_f32_16x16x32_bf16 v[128:131], v[184:187], v[4:7], v[128:131]
    v_cndmask_b32_dpp v194, v170, v174, vcc quad_perm:[1,0,3,2] row_mask:0xf bank_mask:0xf
    v_cndmask_b32_dpp v195, v171, v175, vcc quad_perm:[1,0,3,2] row_mask:0xf bank_mask:0xf
    v_mfma_f32_16x16x32_bf16 v[128:131], v[196:199], v[64:67], v[128:131]
    s_mov_b64 vcc, s[30:31]
    v_cndmask_b32_dpp v188, v172, v168, vcc quad_perm:[1,0,3,2] row_mask:0xf bank_mask:0xf
    v_cndmask_b32_dpp v189, v173, v169, vcc quad_perm:[1,0,3,2] row_mask:0xf bank_mask:0xf
    v_mfma_f32_16x16x32_bf16 v[132:135], v[200:203], v[64:67], 0
    v_cndmask_b32_dpp v190, v174, v170, vcc quad_perm:[1,0,3,2] row_mask:0xf bank_mask:0xf
    v_cndmask_b32_dpp v191, v175, v171, vcc quad_perm:[1,0,3,2] row_mask:0xf bank_mask:0xf
    v_mfma_f32_16x16x32_bf16 v[132:135], v[192:195], v[4:7], v[132:135]
    v_rcp_f32 v220, v220
    v_mfma_f32_16x16x32_bf16 v[116:119], v[140:143], v[204:207], v[116:119]
    v_rcp_f32 v221, v221
    v_mfma_f32_16x16x32_bf16 v[132:135], v[188:191], v[0:3], v[132:135]
    v_exp_f32 v224, -v158
    v_exp_f32 v225, -v159
    v_or_b32_sdwa v152, s36, v152 dst_sel:DWORD dst_unused:UNUSED_PAD src0_sel:DWORD src1_sel:WORD_1
    v_or_b32_sdwa v153, s36, v153 dst_sel:DWORD dst_unused:UNUSED_PAD src0_sel:DWORD src1_sel:WORD_1
    v_or_b32_sdwa v154, s36, v154 dst_sel:DWORD dst_unused:UNUSED_PAD src0_sel:DWORD src1_sel:WORD_1
    v_or_b32_sdwa v155, s36, v155 dst_sel:DWORD dst_unused:UNUSED_PAD src0_sel:DWORD src1_sel:WORD_1
    v_or_b32_sdwa v156, s36, v156 dst_sel:DWORD dst_unused:UNUSED_PAD src0_sel:DWORD src1_sel:WORD_1
    v_or_b32_sdwa v157, s36, v157 dst_sel:DWORD dst_unused:UNUSED_PAD src0_sel:DWORD src1_sel:WORD_1
    v_mul_f32 v220, v220, v150
    ds_read_u16_d16 v152, v152 offset:48383
    ds_read_u16_d16_hi v153, v153 offset:48383
    ds_read_u16_d16 v154, v154 offset:48383
    ds_read_u16_d16_hi v155, v155 offset:48383
    ds_read_u16_d16 v156, v156 offset:48383
    ds_read_u16_d16_hi v157, v157 offset:48383
    buffer_load_dwordx4 v[168:171], v238, s[4:7], 0 offen
    buffer_load_dwordx4 v[172:175], v239, s[4:7], 0 offen
    s_sub_u32 s76, s76, 1
    s_cmp_ge_u32 s76, s78
    s_cbranch_scc1 K_loopa
    s_waitcnt lgkmcnt(0)
    s_branch K_loop
K_drain:
    s_cmp_lg_u32 s83, 0
    s_cbranch_scc1 K_sdrain
    s_setprio 0
    v_mfma_f32_16x16x32_bf16 v[152:155], v[180:183], v[56:59], 0
    v_or_b32_sdwa v145, s36, v145 dst_sel:DWORD dst_unused:UNUSED_PAD src0_sel:DWORD src1_sel:WORD_1
    v_or_b32_sdwa v146, s36, v146 dst_sel:DWORD dst_unused:UNUSED_PAD src0_sel:DWORD src1_sel:WORD_1
    v_mfma_f32_16x16x32_bf16 v[152:155], v[184:187], v[60:63], v[152:155]
    v_or_b32_sdwa v147, s36, v147 dst_sel:DWORD dst_unused:UNUSED_PAD src0_sel:DWORD src1_sel:WORD_1
    v_or_b32_sdwa v148, s36, v148 dst_sel:DWORD dst_unused:UNUSED_PAD src0_sel:DWORD src1_sel:WORD_1
    v_mfma_f32_16x16x32_bf16 v[152:155], v[196:199], v[92:95], v[152:155]
    v_or_b32_sdwa v149, s36, v149 dst_sel:DWORD dst_unused:UNUSED_PAD src0_sel:DWORD src1_sel:WORD_1
    ds_read_u16_d16_hi v145, v145 offset:48383
    v_mfma_f32_16x16x32_bf16 v[156:159], v[188:191], v[56:59], 0
    ds_read_u16_d16 v146, v146 offset:48383
    v_mfma_f32_16x16x32_bf16 v[156:159], v[192:195], v[60:63], v[156:159]
    ds_read_u16_d16_hi v147, v147 offset:48383
    v_mfma_f32_16x16x32_bf16 v[156:159], v[200:203], v[92:95], v[156:159]
    ds_read_u16_d16 v148, v148 offset:48383
    ds_read_u16_d16_hi v149, v149 offset:48383
    s_waitcnt vmcnt(0)
    ds_read_b128 v[160:163], v215 offset:39040
    ds_read_b128 v[164:167], v215 offset:39056
    ds_read_b128 v[168:171], v215 offset:39168
    ds_read_b128 v[172:175], v215 offset:39184
    ds_read_b32 v176, v250 offset:36960
    ds_read_b64_tr_b16 v[0:1], v214 offset:16384
    ds_read_b64_tr_b16 v[2:3], v214 offset:18496
    ds_read_b64_tr_b16 v[4:5], v214 offset:16392
    ds_read_b64_tr_b16 v[6:7], v214 offset:18504
    ds_read_b64_tr_b16 v[8:9], v214 offset:16448
    ds_read_b64_tr_b16 v[10:11], v214 offset:18560
    ds_read_b64_tr_b16 v[12:13], v214 offset:16456
    ds_read_b64_tr_b16 v[14:15], v214 offset:18568
    v_or_b32_sdwa v152, s36, v152 dst_sel:DWORD dst_unused:UNUSED_PAD src0_sel:DWORD src1_sel:WORD_1
    v_or_b32_sdwa v153, s36, v153 dst_sel:DWORD dst_unused:UNUSED_PAD src0_sel:DWORD src1_sel:WORD_1
    v_or_b32_sdwa v154, s36, v154 dst_sel:DWORD dst_unused:UNUSED_PAD src0_sel:DWORD src1_sel:WORD_1
    v_or_b32_sdwa v155, s36, v155 dst_sel:DWORD dst_unused:UNUSED_PAD src0_sel:DWORD src1_sel:WORD_1
    v_or_b32_sdwa v156, s36, v156 dst_sel:DWORD dst_unused:UNUSED_PAD src0_sel:DWORD src1_sel:WORD_1
    v_or_b32_sdwa v157, s36, v157 dst_sel:DWORD dst_unused:UNUSED_PAD src0_sel:DWORD src1_sel:WORD_1
    ds_read_u16_d16 v152, v152 offset:48383
    ds_read_u16_d16_hi v153, v153 offset:48383
    ds_read_u16_d16 v154, v154 offset:48383
    ds_read_u16_d16_hi v155, v155 offset:48383
    ds_read_u16_d16 v156, v156 offset:48383
    ds_read_u16_d16_hi v157, v157 offset:48383
    v_mov_b32 v212, v229
    s_mov_b32 s3, 0xefdfbf7f
    v_cvt_pk_bf16_f32 v64, v96, v97
    v_permlane32_swap_b32 v229, v212
    v_add_u32 v229, v229, v212
    v_mov_b32 v212, v229
    v_cvt_pk_bf16_f32 v65, v98, v99
    v_cvt_pk_bf16_f32 v66, v100, v101
    v_permlane16_swap_b32 v229, v212
    v_add_u32 v229, v229, v212
    v_mul_lo_u32 v229, s3, v229
    v_bfe_u32 v212, v229, 7, 16
    v_lshrrev_b32 v229, 23, v229
    v_add_u32 v212, v212, v229
    v_cvt_f32_u32 v212, v212
    s_waitcnt lgkmcnt(15)
    v_pk_mul_f32 v[160:161], v[160:161], v[212:213] op_sel_hi:[1,0]
    v_pk_mul_f32 v[162:163], v[162:163], v[212:213] op_sel_hi:[1,0]
    v_pk_mul_f32 v[164:165], v[164:165], v[212:213] op_sel_hi:[1,0]
    v_pk_mul_f32 v[166:167], v[166:167], v[212:213] op_sel_hi:[1,0]
    v_pk_mul_f32 v[168:169], v[168:169], v[212:213] op_sel_hi:[1,0]
    v_pk_mul_f32 v[170:171], v[170:171], v[212:213] op_sel_hi:[1,0]
    v_pk_mul_f32 v[172:173], v[172:173], v[212:213] op_sel_hi:[1,0]
    v_pk_mul_f32 v[174:175], v[174:175], v[212:213] op_sel_hi:[1,0]
    v_cvt_pk_bf16_f32 v67, v102, v103
    ds_read_b64_tr_b16 v[16:17], v214 offset:20608
    ds_read_b64_tr_b16 v[18:19], v214 offset:22720
    s_waitcnt lgkmcnt(8)
    v_mfma_f32_16x16x32_bf16 v[160:163], v[0:3], v[64:67], v[160:163]
    ds_read_b64_tr_b16 v[20:21], v214 offset:20616
    v_mfma_f32_16x16x32_bf16 v[164:167], v[4:7], v[64:67], v[164:167]
    ds_read_b64_tr_b16 v[22:23], v214 offset:22728
    v_mfma_f32_16x16x32_bf16 v[168:171], v[8:11], v[64:67], v[168:171]
    ds_read_b64_tr_b16 v[24:25], v214 offset:20672
    v_mfma_f32_16x16x32_bf16 v[172:175], v[12:15], v[64:67], v[172:175]
    ds_read_b64_tr_b16 v[26:27], v214 offset:22784
    ds_read_b64_tr_b16 v[28:29], v214 offset:20680
    ds_read_b64_tr_b16 v[30:31], v214 offset:22792
    v_bitop3_b32 v135, v135, v210, v134 bitop3:0xea
    v_bitop3_b32 v134, v133, v210, v132 bitop3:0xea
    v_bitop3_b32 v133, v131, v210, v130 bitop3:0xea
    v_or_b32 v132, v128, v129
    v_fma_f32 v225, v225, v209, v209
    v_rcp_f32 v224, v224
    v_mfma_f32_16x16x32_bf16 v[112:115], v[132:135], v[204:207], v[112:115]
    v_rcp_f32 v225, v225
    v_mul_f32 v141, v224, v141
    v_mul_f32 v143, v225, v143
    v_bitop3_b32 v143, v143, v210, v142 bitop3:0xea
    v_bitop3_b32 v142, v141, v210, v140 bitop3:0xea
    v_or_b32 v141, v138, v139
    v_or_b32 v140, v136, v137
    v_cvt_pk_bf16_f32 v68, v104, v105
    v_cvt_pk_bf16_f32 v69, v106, v107
    v_mfma_f32_16x16x32_bf16 v[116:119], v[140:143], v[204:207], v[116:119]
    v_cvt_pk_bf16_f32 v70, v108, v109
    v_cvt_pk_bf16_f32 v71, v110, v111
    v_cmp_ne_u32 vcc, 255, v176
    ds_read_b64_tr_b16 v[32:33], v214 offset:24832
    s_waitcnt lgkmcnt(1)
    v_mfma_f32_16x16x32_bf16 v[160:163], v[16:19], v[68:71], v[160:163]
    ds_read_b64_tr_b16 v[34:35], v214 offset:26944
    v_mfma_f32_16x16x32_bf16 v[164:167], v[20:23], v[68:71], v[164:167]
    ds_read_b64_tr_b16 v[36:37], v214 offset:24840
    v_mfma_f32_16x16x32_bf16 v[168:171], v[24:27], v[68:71], v[168:171]
    ds_read_b64_tr_b16 v[38:39], v214 offset:26952
    v_mfma_f32_16x16x32_bf16 v[172:175], v[28:31], v[68:71], v[172:175]
    ds_read_b64_tr_b16 v[40:41], v214 offset:24896
    ds_read_b64_tr_b16 v[42:43], v214 offset:27008
    ds_read_b64_tr_b16 v[44:45], v214 offset:24904
    ds_read_b64_tr_b16 v[46:47], v214 offset:27016
    ds_read_b64_tr_b16 v[48:49], v214 offset:29056
    ds_read_b64_tr_b16 v[50:51], v214 offset:31168
    ds_read_b64_tr_b16 v[52:53], v214 offset:29064
    ds_read_b64_tr_b16 v[54:55], v214 offset:31176
    ds_read_b64_tr_b16 v[56:57], v214 offset:29120
    ds_read_b64_tr_b16 v[58:59], v214 offset:31232
    ds_read_b64_tr_b16 v[60:61], v214 offset:29128
    ds_read_b64_tr_b16 v[62:63], v214 offset:31240
    v_exp_f32 v220, -v150
    v_exp_f32 v221, -v151
    v_add_f32 v220, 1.0, v220
    v_add_f32 v221, 1.0, v221
    v_rcp_f32 v220, v220
    v_rcp_f32 v221, v221
    v_mul_f32 v220, v220, v150
    v_mul_f32 v221, v221, v151
    v_cvt_pk_bf16_f32 v151, v220, v221
    v_cvt_pk_bf16_f32 v72, v112, v113
    v_cvt_pk_bf16_f32 v73, v114, v115
    v_exp_f32 v224, -v158
    v_exp_f32 v225, -v159
    v_add_f32 v224, 1.0, v224
    v_add_f32 v225, 1.0, v225
    v_rcp_f32 v224, v224
    v_rcp_f32 v225, v225
    v_mul_f32 v224, v224, v158
    v_mul_f32 v225, v225, v159
    v_cvt_pk_bf16_f32 v159, v224, v225
    v_or_b32 v150, v148, v149
    v_or_b32 v149, v146, v147
    v_or_b32 v148, v144, v145
    v_or_b32 v158, v156, v157
    v_or_b32 v157, v154, v155
    v_mfma_f32_16x16x32_bf16 v[120:123], v[148:151], v[204:207], v[120:123]
    v_or_b32 v156, v152, v153
    v_cvt_pk_bf16_f32 v74, v116, v117
    v_cvt_pk_bf16_f32 v75, v118, v119
    v_mfma_f32_16x16x32_bf16 v[124:127], v[156:159], v[204:207], v[124:127]
    s_waitcnt lgkmcnt(8)
    v_mfma_f32_16x16x32_bf16 v[160:163], v[32:35], v[72:75], v[160:163]
    v_mfma_f32_16x16x32_bf16 v[164:167], v[36:39], v[72:75], v[164:167]
    v_mfma_f32_16x16x32_bf16 v[168:171], v[40:43], v[72:75], v[168:171]
    v_cvt_pk_bf16_f32 v76, v120, v121
    v_mfma_f32_16x16x32_bf16 v[172:175], v[44:47], v[72:75], v[172:175]
    v_cvt_pk_bf16_f32 v77, v122, v123
    s_nop 0
    v_cvt_pk_bf16_f32 v78, v124, v125
    v_cvt_pk_bf16_f32 v79, v126, v127
    s_waitcnt lgkmcnt(0)
    s_nop 0
    v_mfma_f32_16x16x32_bf16 v[160:163], v[48:51], v[76:79], v[160:163]
    v_mfma_f32_16x16x32_bf16 v[164:167], v[52:55], v[76:79], v[164:167]
    v_mfma_f32_16x16x32_bf16 v[168:171], v[56:59], v[76:79], v[168:171]
    v_mfma_f32_16x16x32_bf16 v[172:175], v[60:63], v[76:79], v[172:175]
K_half_r:
    s_cbranch_vccnz K_epi2
K_xch:
    s_or_b64 exec, s[56:57], s[58:59]
    s_nop 2
    ds_write_b128 v219, v[160:163] offset:0
    ds_write_b128 v219, v[164:167] offset:16
    ds_write_b128 v219, v[168:171] offset:128
    ds_write_b128 v219, v[172:175] offset:144
    s_mov_b64 exec, 0x8080
    ds_add_rtn_u32 v217, v217, v213 offset:36928
    s_mov_b32 s88, 0x3f317218
    s_mov_b32 s89, s88
    s_waitcnt lgkmcnt(0)
    v_cmp_eq_u32 vcc, 1, v217
    s_nop 0
    s_bitcmp1_b32 vcc_lo, 7
    s_cselect_b64 s[56:57], s[56:57], 0
    s_bitcmp1_b32 vcc_lo, 15
    s_cselect_b64 s[58:59], s[58:59], 0
    s_or_b64 exec, s[56:57], s[58:59]
    s_cbranch_scc0 K_xdone
    ds_read_b128 v[128:131], v216 offset:40352
    ds_read_b128 v[132:135], v216 offset:40368
    ds_read_b128 v[136:139], v216 offset:40480
    ds_read_b128 v[140:143], v216 offset:40496
    s_waitcnt lgkmcnt(3)
    v_pk_add_f32 v[160:161], v[160:161], v[128:129]
    v_pk_add_f32 v[162:163], v[162:163], v[130:131]
    s_waitcnt lgkmcnt(2)
    v_pk_add_f32 v[164:165], v[164:165], v[132:133]
    v_pk_add_f32 v[166:167], v[166:167], v[134:135]
    s_waitcnt lgkmcnt(1)
    v_pk_add_f32 v[168:169], v[168:169], v[136:137]
    v_pk_add_f32 v[170:171], v[170:171], v[138:139]
    s_waitcnt lgkmcnt(0)
    v_pk_add_f32 v[172:173], v[172:173], v[140:141]
    v_pk_add_f32 v[174:175], v[174:175], v[142:143]
K_xdone:
    s_or_b64 exec, exec, s[86:87]
    v_pk_mul_f32 v[160:161], v[160:161], s[88:89]
    v_pk_mul_f32 v[162:163], v[162:163], s[88:89]
    v_pk_mul_f32 v[164:165], v[164:165], s[88:89]
    v_pk_mul_f32 v[166:167], v[166:167], s[88:89]
    v_cvt_pk_bf16_f32 v128, v160, v161
    v_cvt_pk_bf16_f32 v129, v162, v163
    v_cvt_pk_bf16_f32 v130, v164, v165
    v_cvt_pk_bf16_f32 v131, v166, v167
    buffer_store_dwordx4 v[128:131], v228, s[16:19], 0 offen offset:0 sc0 sc1 nt
    v_pk_mul_f32 v[168:169], v[168:169], s[88:89]
    v_pk_mul_f32 v[170:171], v[170:171], s[88:89]
    v_pk_mul_f32 v[172:173], v[172:173], s[88:89]
    v_pk_mul_f32 v[174:175], v[174:175], s[88:89]
    v_cvt_pk_bf16_f32 v132, v168, v169
    v_cvt_pk_bf16_f32 v133, v170, v171
    v_cvt_pk_bf16_f32 v134, v172, v173
    v_cvt_pk_bf16_f32 v135, v174, v175
    buffer_store_dwordx4 v[132:135], v228, s[16:19], 0 offen offset:64 sc0 sc1 nt
K_done:
    s_endpgm
K_retry2:
    s_sub_u32 s92, s92, 1
    s_cbranch_scc1 K_panic
    s_mov_b64 exec, s[40:41]
    s_cbranch_execz K_nl0
    buffer_load_dwordx4 v[128:131], v231, s[12:15], s50 offen sc1
    s_bitset0_b32 s49, 0
K_nl0:
    s_mov_b64 exec, s[42:43]
    s_cbranch_execz K_nl1
    buffer_load_dwordx4 v[132:135], v231, s[12:15], s51 offen sc1
    s_bitset0_b32 s49, 1
K_nl1:
    s_mov_b64 exec, s[44:45]
    s_cbranch_execz K_nl2
    buffer_load_dwordx4 v[136:139], v231, s[12:15], s52 offen sc1
    s_bitset0_b32 s49, 2
K_nl2:
    s_mov_b64 exec, s[46:47]
    s_cbranch_execz K_nl3
    buffer_load_dwordx4 v[140:143], v231, s[12:15], s53 offen sc1
    s_bitset0_b32 s49, 3
K_nl3:
    s_mov_b64 exec, -1
    s_cmp_lg_u32 s49, 0
    s_cbranch_scc1 K_proc
K_more:
    s_waitcnt vmcnt(0)
    s_mov_b64 exec, s[40:41]
    s_cbranch_execz K_nc0
    v_xor_b32 v208, v221, v129
    v_xor_b32 v209, v220, v128
    v_bitop3_b32 v208, v130, v222, v208 bitop3:0xbe
    v_bitop3_b32 v208, v131, v223, v208 bitop3:0xbe
    v_bitop3_b32 v208, v224, v208, v209 bitop3:0xca
    v_cmp_lt_u32 s[40:41], s76, v208
K_nc0:
    s_mov_b64 exec, s[42:43]
    s_cbranch_execz K_nc1
    v_xor_b32 v208, v221, v133
    v_xor_b32 v209, v220, v132
    v_bitop3_b32 v208, v134, v222, v208 bitop3:0xbe
    v_bitop3_b32 v208, v135, v223, v208 bitop3:0xbe
    v_bitop3_b32 v208, v224, v208, v209 bitop3:0xca
    v_cmp_lt_u32 s[42:43], s76, v208
K_nc1:
    s_mov_b64 exec, s[44:45]
    s_cbranch_execz K_nc2
    v_xor_b32 v208, v221, v137
    v_xor_b32 v209, v220, v136
    v_bitop3_b32 v208, v138, v222, v208 bitop3:0xbe
    v_bitop3_b32 v208, v139, v223, v208 bitop3:0xbe
    v_bitop3_b32 v208, v224, v208, v209 bitop3:0xca
    v_cmp_lt_u32 s[44:45], s76, v208
K_nc2:
    s_mov_b64 exec, s[46:47]
    s_cbranch_execz K_nc3
    v_xor_b32 v208, v221, v141
    v_xor_b32 v209, v220, v140
    v_bitop3_b32 v208, v142, v222, v208 bitop3:0xbe
    v_bitop3_b32 v208, v143, v223, v208 bitop3:0xbe
    v_bitop3_b32 v208, v224, v208, v209 bitop3:0xca
    v_cmp_lt_u32 s[46:47], s76, v208
K_nc3:
    s_mov_b64 exec, -1
    s_mov_b32 s49, s48
    s_or_b64 s[38:39], s[40:41], s[42:43]
    s_or_b64 s[88:89], s[44:45], s[46:47]
    s_or_b64 s[38:39], s[38:39], s[88:89]
    s_cbranch_scc1 K_retry2
    v_lshrrev_b32 v208, 1, v231
    s_lshl_b32 s3, s29, 12
    s_add_u32 s3, s3, 12582912
    buffer_load_dwordx2 v[210:211], v208, s[12:15], s3 offen sc1 nt
K_ready:
K_proc:
    s_bitcmp1_b32 s49, 0
    s_cbranch_scc0 K_np0
    v_bfe_i32 v251, v128, 24, 4
    v_lshrrev_b32 v186, 1, v129
    v_or_b32 v189, -5, v129
    v_bitop3_b32 v186, v186, v189, 60 bitop3:0x80
    v_lshrrev_b32 v187, 1, v130
    v_or_b32 v190, -5, v130
    v_bitop3_b32 v187, v187, v190, 60 bitop3:0x80
    v_lshrrev_b32 v188, 1, v131
    v_or_b32 v191, -5, v131
    v_bitop3_b32 v188, v188, v191, 60 bitop3:0x80
    v_cmpx_lt_i32 vcc, 0, v251
    ds_add_rtn_u32 v196, v186, v225 offset:36864
    v_cmpx_lt_i32 vcc, 1, v251
    ds_add_rtn_u32 v197, v187, v225 offset:36864
    v_cmpx_lt_i32 vcc, 2, v251
    ds_add_rtn_u32 v198, v188, v225 offset:36864
    s_mov_b64 exec, -1
    v_perm_b32 v144, v128, v129, s78
    v_add3_u32 v144, v144, v236, s82
    v_perm_b32 v145, v128, v130, s79
    v_add3_u32 v145, v145, v236, s85
    v_perm_b32 v128, v128, v131, s80
    v_add3_u32 v128, v128, v236, s90
    v_lshl_or_b32 v144, v129, 25, v144
    v_and_b32 v129, 0x003fff80, v129
    v_lshl_or_b32 v145, v130, 25, v145
    v_and_b32 v130, 0x003fff80, v130
    v_lshl_or_b32 v128, v131, 25, v128
    v_and_b32 v131, 0x003fff80, v131
K_np0:
    s_bitcmp1_b32 s49, 1
    s_cbranch_scc0 K_np1
    v_bfe_i32 v252, v132, 24, 4
    v_lshrrev_b32 v186, 1, v133
    v_or_b32 v189, -5, v133
    v_bitop3_b32 v186, v186, v189, 60 bitop3:0x80
    v_lshrrev_b32 v187, 1, v134
    v_or_b32 v190, -5, v134
    v_bitop3_b32 v187, v187, v190, 60 bitop3:0x80
    v_lshrrev_b32 v188, 1, v135
    v_or_b32 v191, -5, v135
    v_bitop3_b32 v188, v188, v191, 60 bitop3:0x80
    v_cmpx_lt_i32 vcc, 0, v252
    ds_add_rtn_u32 v199, v186, v225 offset:36864
    v_cmpx_lt_i32 vcc, 1, v252
    ds_add_rtn_u32 v200, v187, v225 offset:36864
    v_cmpx_lt_i32 vcc, 2, v252
    ds_add_rtn_u32 v201, v188, v225 offset:36864
    s_mov_b64 exec, -1
    v_perm_b32 v146, v132, v133, s78
    v_add3_u32 v146, v146, v237, s82
    v_perm_b32 v147, v132, v134, s79
    v_add3_u32 v147, v147, v237, s85
    v_perm_b32 v132, v132, v135, s80
    v_add3_u32 v132, v132, v237, s90
    v_lshl_or_b32 v146, v133, 25, v146
    v_and_b32 v133, 0x003fff80, v133
    v_lshl_or_b32 v147, v134, 25, v147
    v_and_b32 v134, 0x003fff80, v134
    v_lshl_or_b32 v132, v135, 25, v132
    v_and_b32 v135, 0x003fff80, v135
K_np1:
    s_bitcmp1_b32 s49, 2
    s_cbranch_scc0 K_np2
    v_bfe_i32 v253, v136, 24, 4
    v_lshrrev_b32 v186, 1, v137
    v_or_b32 v189, -5, v137
    v_bitop3_b32 v186, v186, v189, 60 bitop3:0x80
    v_lshrrev_b32 v187, 1, v138
    v_or_b32 v190, -5, v138
    v_bitop3_b32 v187, v187, v190, 60 bitop3:0x80
    v_lshrrev_b32 v188, 1, v139
    v_or_b32 v191, -5, v139
    v_bitop3_b32 v188, v188, v191, 60 bitop3:0x80
    v_cmpx_lt_i32 vcc, 0, v253
    ds_add_rtn_u32 v202, v186, v225 offset:36864
    v_cmpx_lt_i32 vcc, 1, v253
    ds_add_rtn_u32 v203, v187, v225 offset:36864
    v_cmpx_lt_i32 vcc, 2, v253
    ds_add_rtn_u32 v204, v188, v225 offset:36864
    s_mov_b64 exec, -1
    v_perm_b32 v148, v136, v137, s78
    v_add3_u32 v148, v148, v238, s82
    v_perm_b32 v149, v136, v138, s79
    v_add3_u32 v149, v149, v238, s85
    v_perm_b32 v136, v136, v139, s80
    v_add3_u32 v136, v136, v238, s90
    v_lshl_or_b32 v148, v137, 25, v148
    v_and_b32 v137, 0x003fff80, v137
    v_lshl_or_b32 v149, v138, 25, v149
    v_and_b32 v138, 0x003fff80, v138
    v_lshl_or_b32 v136, v139, 25, v136
    v_and_b32 v139, 0x003fff80, v139
K_np2:
    s_bitcmp1_b32 s49, 3
    s_cbranch_scc0 K_np3
    v_bfe_i32 v254, v140, 24, 4
    v_lshrrev_b32 v186, 1, v141
    v_or_b32 v189, -5, v141
    v_bitop3_b32 v186, v186, v189, 60 bitop3:0x80
    v_lshrrev_b32 v187, 1, v142
    v_or_b32 v190, -5, v142
    v_bitop3_b32 v187, v187, v190, 60 bitop3:0x80
    v_lshrrev_b32 v188, 1, v143
    v_or_b32 v191, -5, v143
    v_bitop3_b32 v188, v188, v191, 60 bitop3:0x80
    v_cmpx_lt_i32 vcc, 0, v254
    ds_add_rtn_u32 v205, v186, v225 offset:36864
    v_cmpx_lt_i32 vcc, 1, v254
    ds_add_rtn_u32 v206, v187, v225 offset:36864
    v_cmpx_lt_i32 vcc, 2, v254
    ds_add_rtn_u32 v207, v188, v225 offset:36864
    s_mov_b64 exec, -1
    v_perm_b32 v150, v140, v141, s78
    v_add3_u32 v150, v150, v239, s82
    v_perm_b32 v151, v140, v142, s79
    v_add3_u32 v151, v151, v239, s85
    v_perm_b32 v140, v140, v143, s80
    v_add3_u32 v140, v140, v239, s90
    v_lshl_or_b32 v150, v141, 25, v150
    v_and_b32 v141, 0x003fff80, v141
    v_lshl_or_b32 v151, v142, 25, v151
    v_and_b32 v142, 0x003fff80, v142
    v_lshl_or_b32 v140, v143, 25, v140
    v_and_b32 v143, 0x003fff80, v143
K_np3:
    s_waitcnt lgkmcnt(0)
    s_bitcmp1_b32 s49, 0
    s_cbranch_scc0 K_nu0
    v_min_u32_sdwa v196, v196, v226 dst_sel:WORD_0 dst_unused:UNUSED_PAD src0_sel:DWORD src1_sel:DWORD
    v_min_u32_sdwa v197, v197, v226 dst_sel:WORD_0 dst_unused:UNUSED_PAD src0_sel:DWORD src1_sel:DWORD
    v_min_u32_sdwa v198, v198, v226 dst_sel:WORD_0 dst_unused:UNUSED_PAD src0_sel:DWORD src1_sel:DWORD
    ds_write2st64_b32 v196, v129, v144 offset0:128 offset1:221
    ds_write2st64_b32 v197, v130, v145 offset0:128 offset1:221
    ds_write2st64_b32 v198, v131, v128 offset0:128 offset1:221
K_nu0:
    s_bitcmp1_b32 s49, 1
    s_cbranch_scc0 K_nu1
    v_min_u32_sdwa v199, v199, v226 dst_sel:WORD_0 dst_unused:UNUSED_PAD src0_sel:DWORD src1_sel:DWORD
    v_min_u32_sdwa v200, v200, v226 dst_sel:WORD_0 dst_unused:UNUSED_PAD src0_sel:DWORD src1_sel:DWORD
    v_min_u32_sdwa v201, v201, v226 dst_sel:WORD_0 dst_unused:UNUSED_PAD src0_sel:DWORD src1_sel:DWORD
    ds_write2st64_b32 v199, v133, v146 offset0:128 offset1:221
    ds_write2st64_b32 v200, v134, v147 offset0:128 offset1:221
    ds_write2st64_b32 v201, v135, v132 offset0:128 offset1:221
K_nu1:
    s_bitcmp1_b32 s49, 2
    s_cbranch_scc0 K_nu2
    v_min_u32_sdwa v202, v202, v226 dst_sel:WORD_0 dst_unused:UNUSED_PAD src0_sel:DWORD src1_sel:DWORD
    v_min_u32_sdwa v203, v203, v226 dst_sel:WORD_0 dst_unused:UNUSED_PAD src0_sel:DWORD src1_sel:DWORD
    v_min_u32_sdwa v204, v204, v226 dst_sel:WORD_0 dst_unused:UNUSED_PAD src0_sel:DWORD src1_sel:DWORD
    ds_write2st64_b32 v202, v137, v148 offset0:128 offset1:221
    ds_write2st64_b32 v203, v138, v149 offset0:128 offset1:221
    ds_write2st64_b32 v204, v139, v136 offset0:128 offset1:221
K_nu2:
    s_bitcmp1_b32 s49, 3
    s_cbranch_scc0 K_nu3
    v_min_u32_sdwa v205, v205, v226 dst_sel:WORD_0 dst_unused:UNUSED_PAD src0_sel:DWORD src1_sel:DWORD
    v_min_u32_sdwa v206, v206, v226 dst_sel:WORD_0 dst_unused:UNUSED_PAD src0_sel:DWORD src1_sel:DWORD
    v_min_u32_sdwa v207, v207, v226 dst_sel:WORD_0 dst_unused:UNUSED_PAD src0_sel:DWORD src1_sel:DWORD
    ds_write2st64_b32 v205, v141, v150 offset0:128 offset1:221
    ds_write2st64_b32 v206, v142, v151 offset0:128 offset1:221
    ds_write2st64_b32 v207, v143, v140 offset0:128 offset1:221
K_nu3:
    s_andn2_b32 s48, s48, s49
    s_cbranch_scc1 K_more
    s_branch K_placed
K_spread:
    s_cmp_lt_u32 s79, 128
    s_cbranch_scc1 K_spread_r
    s_cmp_lt_u32 s76, 3
    s_cbranch_scc1 K_spread_r
    s_lshl_b32 s3, s76, 7
    v_and_b32 v152, 28, v255
    v_and_b32 v153, 3, v255
    s_add_u32 s3, s3, s54
    v_fma_f32 v152, v152, 0.5, v153
    v_and_b32 v153, 2, v255
    s_sub_u32 s3, s3, 128
    v_fmamk_f32 v152, v153, 0x40e00000, v152
    s_mov_b32 exec_hi, 0
    v_lshl_add_u32 v152, v152, 2, s3
    v_add_u32 v154, s3, v140
    ds_read2st64_b32 v[152:153], v152 offset0:128 offset1:221
    s_mov_b32 s62, 1
    s_waitcnt lgkmcnt(0)
    ds_write2st64_b32 v154, v152, v153 offset0:128 offset1:221
    s_mov_b64 exec, -1
    s_branch K_spread_r
K_half:
    s_waitcnt lgkmcnt(6)
    v_mul_f32 v221, v221, v151
    v_add_f32 v224, 1.0, v224
    v_add_f32 v225, 1.0, v225
    v_or_b32 v150, v148, v149
    v_or_b32 v149, v146, v147
    v_or_b32 v148, v144, v145
    v_mfma_f32_16x16x32_bf16 v[136:139], v[196:199], v[68:71], 0
    s_setprio 1
    v_cvt_pk_bf16_f32 v151, v220, v221
    v_or_b32_sdwa v128, s36, v128 dst_sel:DWORD dst_unused:UNUSED_PAD src0_sel:DWORD src1_sel:WORD_1
    v_mfma_f32_16x16x32_bf16 v[136:139], v[180:183], v[8:11], v[136:139]
    v_rcp_f32 v224, v224
    v_mfma_f32_16x16x32_bf16 v[136:139], v[184:187], v[12:15], v[136:139]
    v_rcp_f32 v225, v225
    v_mfma_f32_16x16x32_bf16 v[120:123], v[148:151], v[204:207], v[120:123]
    s_setprio 2
    v_or_b32_sdwa v129, s36, v129 dst_sel:DWORD dst_unused:UNUSED_PAD src0_sel:DWORD src1_sel:WORD_1
    v_or_b32_sdwa v130, s36, v130 dst_sel:DWORD dst_unused:UNUSED_PAD src0_sel:DWORD src1_sel:WORD_1
    v_or_b32_sdwa v131, s36, v131 dst_sel:DWORD dst_unused:UNUSED_PAD src0_sel:DWORD src1_sel:WORD_1
    s_nop 1
    v_or_b32_sdwa v136, s36, v136 dst_sel:DWORD dst_unused:UNUSED_PAD src0_sel:DWORD src1_sel:WORD_1
    v_mul_f32 v224, v224, v158
    v_mul_f32 v225, v225, v159
    s_setprio 0
    ds_read_u16_d16 v128, v128 offset:48383
    ds_read_u16_d16_hi v129, v129 offset:48383
    ds_read_u16_d16 v130, v130 offset:48383
    ds_read_u16_d16_hi v131, v131 offset:48383
    ds_read_u16_d16 v136, v136 offset:48383
    s_waitcnt lgkmcnt(5)
    v_or_b32 v158, v156, v157
    v_or_b32 v157, v154, v155
    v_or_b32 v156, v152, v153
    v_mfma_f32_16x16x32_bf16 v[144:147], v[196:199], v[72:75], 0
    s_setprio 1
    v_cvt_pk_bf16_f32 v159, v224, v225
    v_or_b32_sdwa v137, s36, v137 dst_sel:DWORD dst_unused:UNUSED_PAD src0_sel:DWORD src1_sel:WORD_1
    v_mfma_f32_16x16x32_bf16 v[144:147], v[180:183], v[16:19], v[144:147]
    v_mfma_f32_16x16x32_bf16 v[144:147], v[184:187], v[20:23], v[144:147]
    v_mfma_f32_16x16x32_bf16 v[124:127], v[156:159], v[204:207], v[124:127]
    s_setprio 2
    v_or_b32_sdwa v138, s36, v138 dst_sel:DWORD dst_unused:UNUSED_PAD src0_sel:DWORD src1_sel:WORD_1
    v_or_b32_sdwa v139, s36, v139 dst_sel:DWORD dst_unused:UNUSED_PAD src0_sel:DWORD src1_sel:WORD_1
    s_nop 3
    v_or_b32_sdwa v144, s36, v144 dst_sel:DWORD dst_unused:UNUSED_PAD src0_sel:DWORD src1_sel:WORD_1
    s_setprio 0
    ds_read_b64_tr_b16 v[204:205], v246
    ds_read_b64_tr_b16 v[206:207], v246 offset:48
    ds_read_u16_d16_hi v137, v137 offset:48383
    ds_read_u16_d16 v138, v138 offset:48383
    ds_read_u16_d16_hi v139, v139 offset:48383
    ds_read_u16_d16 v144, v144 offset:48383
    s_waitcnt lgkmcnt(7)
    v_or_b32 v133, v130, v131
    v_or_b32 v132, v128, v129
    v_mfma_f32_16x16x32_bf16 v[152:155], v[196:199], v[76:79], 0
    s_setprio 1
    v_mfma_f32_16x16x32_bf16 v[152:155], v[180:183], v[24:27], v[152:155]
    v_mfma_f32_16x16x32_bf16 v[152:155], v[184:187], v[28:31], v[152:155]
    s_waitcnt lgkmcnt(4)
    v_mfma_f32_16x16x32_bf16 v[96:99], v[132:135], v[204:207], v[96:99]
    s_setprio 2
    v_or_b32_sdwa v145, s36, v145 dst_sel:DWORD dst_unused:UNUSED_PAD src0_sel:DWORD src1_sel:WORD_1
    v_or_b32_sdwa v146, s36, v146 dst_sel:DWORD dst_unused:UNUSED_PAD src0_sel:DWORD src1_sel:WORD_1
    v_or_b32_sdwa v147, s36, v147 dst_sel:DWORD dst_unused:UNUSED_PAD src0_sel:DWORD src1_sel:WORD_1
    s_nop 1
    v_or_b32_sdwa v152, s36, v152 dst_sel:DWORD dst_unused:UNUSED_PAD src0_sel:DWORD src1_sel:WORD_1
    s_setprio 0
    ds_read_u16_d16_hi v145, v145 offset:48383
    ds_read_u16_d16 v146, v146 offset:48383
    ds_read_u16_d16_hi v147, v147 offset:48383
    ds_read_u16_d16 v152, v152 offset:48383
    s_waitcnt lgkmcnt(5)
    v_or_b32 v141, v138, v139
    v_or_b32 v140, v136, v137
    v_mfma_f32_16x16x32_bf16 v[128:131], v[196:199], v[80:83], 0
    s_setprio 1
    v_or_b32_sdwa v153, s36, v153 dst_sel:DWORD dst_unused:UNUSED_PAD src0_sel:DWORD src1_sel:WORD_1
    v_mfma_f32_16x16x32_bf16 v[128:131], v[180:183], v[32:35], v[128:131]
    v_mfma_f32_16x16x32_bf16 v[128:131], v[184:187], v[36:39], v[128:131]
    v_mfma_f32_16x16x32_bf16 v[100:103], v[140:143], v[204:207], v[100:103]
    s_setprio 2
    v_or_b32_sdwa v154, s36, v154 dst_sel:DWORD dst_unused:UNUSED_PAD src0_sel:DWORD src1_sel:WORD_1
    v_or_b32_sdwa v155, s36, v155 dst_sel:DWORD dst_unused:UNUSED_PAD src0_sel:DWORD src1_sel:WORD_1
    v_add3_u32 v229, v204, v205, v229
    s_nop 2
    v_or_b32_sdwa v128, s36, v128 dst_sel:DWORD dst_unused:UNUSED_PAD src0_sel:DWORD src1_sel:WORD_1
    s_setprio 0
    ds_read_u16_d16_hi v153, v153 offset:48383
    ds_read_u16_d16 v154, v154 offset:48383
    ds_read_u16_d16_hi v155, v155 offset:48383
    ds_read_u16_d16 v128, v128 offset:48383
    s_waitcnt lgkmcnt(5)
    v_or_b32 v149, v146, v147
    v_or_b32 v148, v144, v145
    v_mfma_f32_16x16x32_bf16 v[136:139], v[196:199], v[84:87], 0
    s_setprio 1
    v_or_b32_sdwa v129, s36, v129 dst_sel:DWORD dst_unused:UNUSED_PAD src0_sel:DWORD src1_sel:WORD_1
    v_mfma_f32_16x16x32_bf16 v[136:139], v[180:183], v[40:43], v[136:139]
    v_mfma_f32_16x16x32_bf16 v[136:139], v[184:187], v[44:47], v[136:139]
    v_exp_f32 v220, -v131
    v_mfma_f32_16x16x32_bf16 v[104:107], v[148:151], v[204:207], v[104:107]
    s_setprio 2
    v_or_b32_sdwa v130, s36, v130 dst_sel:DWORD dst_unused:UNUSED_PAD src0_sel:DWORD src1_sel:WORD_1
    v_add3_u32 v229, v206, v207, v229
    s_setprio 0
    ds_read_u16_d16_hi v129, v129 offset:48383
    ds_read_u16_d16 v130, v130 offset:48383
    s_waitcnt lgkmcnt(3)
    v_fma_f32 v220, v220, v209, v209
    v_or_b32 v157, v154, v155
    v_or_b32 v156, v152, v153
    v_mfma_f32_16x16x32_bf16 v[144:147], v[196:199], v[88:91], 0
    s_setprio 1
    v_mfma_f32_16x16x32_bf16 v[144:147], v[180:183], v[48:51], v[144:147]
    v_rcp_f32 v220, v220
    v_mfma_f32_16x16x32_bf16 v[144:147], v[184:187], v[52:55], v[144:147]
    v_mfma_f32_16x16x32_bf16 v[108:111], v[156:159], v[204:207], v[108:111]
    s_setprio 2
    v_or_b32_sdwa v136, s36, v136 dst_sel:DWORD dst_unused:UNUSED_PAD src0_sel:DWORD src1_sel:WORD_1
    v_or_b32_sdwa v137, s36, v137 dst_sel:DWORD dst_unused:UNUSED_PAD src0_sel:DWORD src1_sel:WORD_1
    v_or_b32_sdwa v138, s36, v138 dst_sel:DWORD dst_unused:UNUSED_PAD src0_sel:DWORD src1_sel:WORD_1
    v_or_b32_sdwa v139, s36, v139 dst_sel:DWORD dst_unused:UNUSED_PAD src0_sel:DWORD src1_sel:WORD_1
    s_nop 1
    v_or_b32_sdwa v144, s36, v144 dst_sel:DWORD dst_unused:UNUSED_PAD src0_sel:DWORD src1_sel:WORD_1
    v_mul_f32 v131, v220, v131
    s_setprio 0
    ds_read_u16_d16 v136, v136 offset:48383
    ds_read_u16_d16_hi v137, v137 offset:48383
    ds_read_u16_d16 v138, v138 offset:48383
    ds_read_u16_d16_hi v139, v139 offset:48383
    ds_read_u16_d16 v144, v144 offset:48383
    s_setprio 0
    v_mfma_f32_16x16x32_bf16 v[152:155], v[180:183], v[56:59], 0
    v_or_b32_sdwa v145, s36, v145 dst_sel:DWORD dst_unused:UNUSED_PAD src0_sel:DWORD src1_sel:WORD_1
    v_or_b32_sdwa v146, s36, v146 dst_sel:DWORD dst_unused:UNUSED_PAD src0_sel:DWORD src1_sel:WORD_1
    v_mfma_f32_16x16x32_bf16 v[152:155], v[184:187], v[60:63], v[152:155]
    v_or_b32_sdwa v147, s36, v147 dst_sel:DWORD dst_unused:UNUSED_PAD src0_sel:DWORD src1_sel:WORD_1
    ds_read_u16_d16_hi v145, v145 offset:48383
    v_mfma_f32_16x16x32_bf16 v[152:155], v[196:199], v[92:95], v[152:155]
    ds_read_u16_d16 v146, v146 offset:48383
    ds_read_u16_d16_hi v147, v147 offset:48383
    s_waitcnt vmcnt(0)
    ds_read_b128 v[160:163], v215 offset:39040
    ds_read_b128 v[164:167], v215 offset:39056
    ds_read_b128 v[168:171], v215 offset:39168
    ds_read_b128 v[172:175], v215 offset:39184
    ds_read_b32 v176, v250 offset:36960
    ds_read_b64_tr_b16 v[0:1], v214 offset:16384
    ds_read_b64_tr_b16 v[2:3], v214 offset:18496
    ds_read_b64_tr_b16 v[4:5], v214 offset:16392
    ds_read_b64_tr_b16 v[6:7], v214 offset:18504
    ds_read_b64_tr_b16 v[8:9], v214 offset:16448
    ds_read_b64_tr_b16 v[10:11], v214 offset:18560
    ds_read_b64_tr_b16 v[12:13], v214 offset:16456
    ds_read_b64_tr_b16 v[14:15], v214 offset:18568
    v_or_b32_sdwa v152, s36, v152 dst_sel:DWORD dst_unused:UNUSED_PAD src0_sel:DWORD src1_sel:WORD_1
    v_or_b32_sdwa v153, s36, v153 dst_sel:DWORD dst_unused:UNUSED_PAD src0_sel:DWORD src1_sel:WORD_1
    v_or_b32_sdwa v154, s36, v154 dst_sel:DWORD dst_unused:UNUSED_PAD src0_sel:DWORD src1_sel:WORD_1
    v_or_b32_sdwa v155, s36, v155 dst_sel:DWORD dst_unused:UNUSED_PAD src0_sel:DWORD src1_sel:WORD_1
    ds_read_u16_d16 v152, v152 offset:48383
    ds_read_u16_d16_hi v153, v153 offset:48383
    ds_read_u16_d16 v154, v154 offset:48383
    ds_read_u16_d16_hi v155, v155 offset:48383
    v_mov_b32 v212, v229
    s_mov_b32 s3, 0xefdfbf7f
    v_cvt_pk_bf16_f32 v64, v96, v97
    v_permlane32_swap_b32 v229, v212
    v_add_u32 v229, v229, v212
    v_mov_b32 v212, v229
    v_cvt_pk_bf16_f32 v65, v98, v99
    v_cvt_pk_bf16_f32 v66, v100, v101
    v_permlane16_swap_b32 v229, v212
    v_add_u32 v229, v229, v212
    v_mul_lo_u32 v229, s3, v229
    v_bfe_u32 v212, v229, 7, 16
    v_lshrrev_b32 v229, 23, v229
    v_add_u32 v212, v212, v229
    v_cvt_f32_u32 v212, v212
    s_waitcnt lgkmcnt(13)
    v_pk_mul_f32 v[160:161], v[160:161], v[212:213] op_sel_hi:[1,0]
    v_pk_mul_f32 v[162:163], v[162:163], v[212:213] op_sel_hi:[1,0]
    v_pk_mul_f32 v[164:165], v[164:165], v[212:213] op_sel_hi:[1,0]
    v_pk_mul_f32 v[166:167], v[166:167], v[212:213] op_sel_hi:[1,0]
    v_pk_mul_f32 v[168:169], v[168:169], v[212:213] op_sel_hi:[1,0]
    v_pk_mul_f32 v[170:171], v[170:171], v[212:213] op_sel_hi:[1,0]
    v_pk_mul_f32 v[172:173], v[172:173], v[212:213] op_sel_hi:[1,0]
    v_pk_mul_f32 v[174:175], v[174:175], v[212:213] op_sel_hi:[1,0]
    v_cvt_pk_bf16_f32 v67, v102, v103
    ds_read_b64_tr_b16 v[16:17], v214 offset:20608
    ds_read_b64_tr_b16 v[18:19], v214 offset:22720
    s_waitcnt lgkmcnt(6)
    v_mfma_f32_16x16x32_bf16 v[160:163], v[0:3], v[64:67], v[160:163]
    ds_read_b64_tr_b16 v[20:21], v214 offset:20616
    v_mfma_f32_16x16x32_bf16 v[164:167], v[4:7], v[64:67], v[164:167]
    ds_read_b64_tr_b16 v[22:23], v214 offset:22728
    v_mfma_f32_16x16x32_bf16 v[168:171], v[8:11], v[64:67], v[168:171]
    ds_read_b64_tr_b16 v[24:25], v214 offset:20672
    v_mfma_f32_16x16x32_bf16 v[172:175], v[12:15], v[64:67], v[172:175]
    ds_read_b64_tr_b16 v[26:27], v214 offset:22784
    ds_read_b64_tr_b16 v[28:29], v214 offset:20680
    ds_read_b64_tr_b16 v[30:31], v214 offset:22792
    v_bitop3_b32 v133, v131, v210, v130 bitop3:0xea
    v_or_b32 v132, v128, v129
    v_or_b32 v141, v138, v139
    v_or_b32 v140, v136, v137
    v_mfma_f32_16x16x32_bf16 v[112:115], v[132:135], v[204:207], v[112:115]
    v_cvt_pk_bf16_f32 v68, v104, v105
    v_cvt_pk_bf16_f32 v69, v106, v107
    v_mfma_f32_16x16x32_bf16 v[116:119], v[140:143], v[204:207], v[116:119]
    v_cvt_pk_bf16_f32 v70, v108, v109
    v_cvt_pk_bf16_f32 v71, v110, v111
    v_cmp_ne_u32 vcc, 255, v176
    ds_read_b64_tr_b16 v[32:33], v214 offset:24832
    ds_read_b64_tr_b16 v[34:35], v214 offset:26944
    ds_read_b64_tr_b16 v[36:37], v214 offset:24840
    ds_read_b64_tr_b16 v[38:39], v214 offset:26952
    ds_read_b64_tr_b16 v[40:41], v214 offset:24896
    ds_read_b64_tr_b16 v[42:43], v214 offset:27008
    ds_read_b64_tr_b16 v[44:45], v214 offset:24904
    s_waitcnt lgkmcnt(7)
    v_mfma_f32_16x16x32_bf16 v[160:163], v[16:19], v[68:71], v[160:163]
    ds_read_b64_tr_b16 v[46:47], v214 offset:27016
    v_mfma_f32_16x16x32_bf16 v[164:167], v[20:23], v[68:71], v[164:167]
    ds_read_b64_tr_b16 v[48:49], v214 offset:29056
    v_mfma_f32_16x16x32_bf16 v[168:171], v[24:27], v[68:71], v[168:171]
    ds_read_b64_tr_b16 v[50:51], v214 offset:31168
    v_mfma_f32_16x16x32_bf16 v[172:175], v[28:31], v[68:71], v[172:175]
    ds_read_b64_tr_b16 v[52:53], v214 offset:29064
    ds_read_b64_tr_b16 v[54:55], v214 offset:31176
    ds_read_b64_tr_b16 v[56:57], v214 offset:29120
    ds_read_b64_tr_b16 v[58:59], v214 offset:31232
    ds_read_b64_tr_b16 v[60:61], v214 offset:29128
    ds_read_b64_tr_b16 v[62:63], v214 offset:31240
    v_cvt_pk_bf16_f32 v72, v112, v113
    v_cvt_pk_bf16_f32 v73, v114, v115
    v_or_b32 v149, v146, v147
    v_or_b32 v148, v144, v145
    v_or_b32 v157, v154, v155
    v_or_b32 v156, v152, v153
    v_mfma_f32_16x16x32_bf16 v[120:123], v[148:151], v[204:207], v[120:123]
    v_cvt_pk_bf16_f32 v74, v116, v117
    v_cvt_pk_bf16_f32 v75, v118, v119
    v_mfma_f32_16x16x32_bf16 v[124:127], v[156:159], v[204:207], v[124:127]
    s_waitcnt lgkmcnt(8)
    v_mfma_f32_16x16x32_bf16 v[160:163], v[32:35], v[72:75], v[160:163]
    v_mfma_f32_16x16x32_bf16 v[164:167], v[36:39], v[72:75], v[164:167]
    v_mfma_f32_16x16x32_bf16 v[168:171], v[40:43], v[72:75], v[168:171]
    v_mfma_f32_16x16x32_bf16 v[172:175], v[44:47], v[72:75], v[172:175]
    v_cvt_pk_bf16_f32 v76, v120, v121
    v_cvt_pk_bf16_f32 v77, v122, v123
    s_nop 0
    v_cvt_pk_bf16_f32 v78, v124, v125
    v_cvt_pk_bf16_f32 v79, v126, v127
    s_waitcnt lgkmcnt(0)
    s_nop 0
    v_mfma_f32_16x16x32_bf16 v[160:163], v[48:51], v[76:79], v[160:163]
    v_mfma_f32_16x16x32_bf16 v[164:167], v[52:55], v[76:79], v[164:167]
    v_mfma_f32_16x16x32_bf16 v[168:171], v[56:59], v[76:79], v[168:171]
    v_mfma_f32_16x16x32_bf16 v[172:175], v[60:63], v[76:79], v[172:175]
    s_branch K_half_r
K_four:
    s_mov_b64 exec, -1
    v_add_u32 v143, 768, v140
    v_cmpx_gt_u32 vcc, s80, v143
    ds_read2st64_b32 v[158:159], v145 offset0:131 offset1:224
    s_mov_b64 exec, -1
    s_waitcnt lgkmcnt(0)
    v_add_u32 v159, v159, v148
    v_cmpx_gt_u32 vcc, s79, v143
    ds_write2st64_b32 v146, v158, v159 offset0:131 offset1:224
    s_branch K_four_r
K_plate:
    ds_read_b32 v128, v12 offset:16
    ds_read_u8 v129, v12 offset:3
    ds_read_b32 v130, v12 offset:17424
    ds_read_u8 v131, v12 offset:17411
    ds_read_b32 v132, v12 offset:34832
    ds_read_u8 v133, v12 offset:34819
    ds_read_b32 v134, v12 offset:52240
    ds_read_u8 v135, v12 offset:52227
    s_lshr_b32 s38, s74, 6
    s_lshr_b32 s3, s75, 12
    s_or_b32 s38, s38, s3
    s_or_b32 s3, s72, s73
    s_or_b32 s38, s38, s3
    s_waitcnt lgkmcnt(0)
    v_subrev_u32 v204, 25, v204
    v_cmp_gt_u32 vcc, 8, v204
    s_nop 0
    s_cbranch_vccz K_pl0
    v_and_or_b32 v128, v128, s76, v125
    v_or_b32 v129, s38, v129
    v_bfe_u32 v152, v8, 13, 2
    v_lshl_or_b32 v129, v152, 8, v129
    v_lshlrev_b32 v152, 22, v152
    v_xor_b32 v128, v152, v128
    v_lshrrev_b32 v152, 15, v8
    v_lshrrev_b32 v8, 1, v8
    v_and_b32 v153, 4095, v8
    v_lshl_or_b32 v152, v152, 12, v153
    s_mov_b32 s3, 8388608
    s_mov_b32 s39, 12582912
    s_mov_b64 exec, vcc
    buffer_store_dwordx2 v[128:129], v152, s[12:15], s39 offen sc1
    buffer_store_dwordx2 v[128:129], v8, s[12:15], s3 offen sc1
    s_mov_b64 exec, -1
K_pl0:
    v_subrev_u32 v205, 25, v205
    v_cmp_gt_u32 vcc, 8, v205
    s_nop 0
    s_cbranch_vccz K_pl1
    v_and_or_b32 v130, v130, s76, v125
    v_or_b32 v131, s38, v131
    v_bfe_u32 v152, v9, 13, 2
    v_lshl_or_b32 v131, v152, 8, v131
    v_lshlrev_b32 v152, 22, v152
    v_xor_b32 v130, v152, v130
    v_lshrrev_b32 v152, 15, v9
    v_lshrrev_b32 v9, 1, v9
    v_and_b32 v153, 4095, v9
    v_lshl_or_b32 v152, v152, 12, v153
    s_mov_b32 s3, 9437184
    s_mov_b32 s39, 12845056
    s_mov_b64 exec, vcc
    buffer_store_dwordx2 v[130:131], v152, s[12:15], s39 offen sc1
    buffer_store_dwordx2 v[130:131], v9, s[12:15], s3 offen sc1
    s_mov_b64 exec, -1
K_pl1:
    v_subrev_u32 v206, 25, v206
    v_cmp_gt_u32 vcc, 8, v206
    s_nop 0
    s_cbranch_vccz K_pl2
    v_and_or_b32 v132, v132, s76, v125
    v_or_b32 v133, s38, v133
    v_bfe_u32 v152, v10, 13, 2
    v_lshl_or_b32 v133, v152, 8, v133
    v_lshlrev_b32 v152, 22, v152
    v_xor_b32 v132, v152, v132
    v_lshrrev_b32 v152, 15, v10
    v_lshrrev_b32 v10, 1, v10
    v_and_b32 v153, 4095, v10
    v_lshl_or_b32 v152, v152, 12, v153
    s_mov_b32 s3, 10485760
    s_mov_b32 s39, 13107200
    s_mov_b64 exec, vcc
    buffer_store_dwordx2 v[132:133], v152, s[12:15], s39 offen sc1
    buffer_store_dwordx2 v[132:133], v10, s[12:15], s3 offen sc1
    s_mov_b64 exec, -1
K_pl2:
    v_subrev_u32 v207, 25, v207
    v_cmp_gt_u32 vcc, 8, v207
    s_nop 0
    s_cbranch_vccz K_pl3
    v_and_or_b32 v134, v134, s76, v125
    v_or_b32 v135, s38, v135
    v_bfe_u32 v152, v11, 13, 2
    v_lshl_or_b32 v135, v152, 8, v135
    v_lshlrev_b32 v152, 22, v152
    v_xor_b32 v134, v152, v134
    v_lshrrev_b32 v152, 15, v11
    v_lshrrev_b32 v11, 1, v11
    v_and_b32 v153, 4095, v11
    v_lshl_or_b32 v152, v152, 12, v153
    s_mov_b32 s3, 11534336
    s_mov_b32 s39, 13369344
    s_mov_b64 exec, vcc
    buffer_store_dwordx2 v[134:135], v152, s[12:15], s39 offen sc1
    buffer_store_dwordx2 v[134:135], v11, s[12:15], s3 offen sc1
    s_mov_b64 exec, -1
K_pl3:
    s_cbranch_execz K_dry
    s_waitcnt vmcnt(6)
    s_branch K_pubdone
K_flag:
    v_cmp_lt_i32 s[64:65], 3, v251
    v_cmp_lt_i32 s[66:67], 3, v252
    v_cmp_lt_i32 s[68:69], 3, v253
    v_cmp_lt_i32 s[70:71], 3, v254
    s_mov_b32 s0, 1
    v_cmp_gt_i32 vcc, 0, v208
    s_nop 0
    s_cbranch_vccnz K_ovf
K_ovf_r:
    s_waitcnt vmcnt(5)
    s_and_b32 s3, s77, s48
    s_cbranch_scc1 K_l3ok
    s_waitcnt vmcnt(0)
K_l3ok:
    v_mov_b64 v[152:153], v[210:211]
    v_mov_b64 v[154:155], v[210:211]
    v_mov_b64 v[156:157], v[210:211]
    v_mov_b64 v[158:159], v[210:211]
K_late_chk:
    s_lshr_b32 s38, s74, 6
    s_lshr_b32 s3, s75, 12
    s_or_b32 s38, s38, s3
    s_or_b32 s3, s72, s73
    s_or_b32 s38, s38, s3
    s_mov_b64 s[88:89], 0
    s_mov_b64 exec, s[64:65]
    s_cbranch_execz K_lc0
    s_xor_b32 s3, s73, 0
    s_or_b32 s39, s38, 0
    v_xor_b32 v208, s3, v152
    v_xor_b32 v209, s39, v153
    v_and_or_b32 v208, v208, s91, v209
    v_cmp_lt_u32 vcc, 255, v208
    s_nop 0
    s_or_b64 s[88:89], s[88:89], vcc
K_lc0:
    s_mov_b64 exec, s[66:67]
    s_cbranch_execz K_lc1
    s_xor_b32 s3, s73, 4194304
    s_or_b32 s39, s38, 256
    v_xor_b32 v208, s3, v154
    v_xor_b32 v209, s39, v155
    v_and_or_b32 v208, v208, s91, v209
    v_cmp_lt_u32 vcc, 255, v208
    s_nop 0
    s_or_b64 s[88:89], s[88:89], vcc
K_lc1:
    s_mov_b64 exec, s[68:69]
    s_cbranch_execz K_lc2
    s_xor_b32 s3, s73, 8388608
    s_or_b32 s39, s38, 512
    v_xor_b32 v208, s3, v156
    v_xor_b32 v209, s39, v157
    v_and_or_b32 v208, v208, s91, v209
    v_cmp_lt_u32 vcc, 255, v208
    s_nop 0
    s_or_b64 s[88:89], s[88:89], vcc
K_lc2:
    s_mov_b64 exec, s[70:71]
    s_cbranch_execz K_lc3
    s_xor_b32 s3, s73, 12582912
    s_or_b32 s39, s38, 768
    v_xor_b32 v208, s3, v158
    v_xor_b32 v209, s39, v159
    v_and_or_b32 v208, v208, s91, v209
    v_cmp_lt_u32 vcc, 255, v208
    s_nop 0
    s_or_b64 s[88:89], s[88:89], vcc
K_lc3:
    s_mov_b64 exec, -1
    s_cmp_lg_u64 s[88:89], 0
    s_cbranch_scc1 K_l2retry
    v_mov_b64 v[208:209], -1
    v_mov_b64 v[210:211], -1
    s_mov_b64 exec, s[64:65]
    s_cbranch_execz K_ld12
    v_lshrrev_b32 v186, 1, v152
    v_or_b32 v187, -5, v152
    v_bitop3_b32 v186, v186, v187, 60 bitop3:0x80
    ds_add_rtn_u32 v208, v186, v225 offset:36864
    v_perm_b32 v153, v153, v152, s78
    v_add3_u32 v153, v153, v236, s82
    v_lshl_or_b32 v153, v152, 25, v153
    v_and_b32 v152, 0x003fff80, v152
K_ld12:
    s_mov_b64 exec, s[66:67]
    s_cbranch_execz K_ld13
    v_lshrrev_b32 v186, 1, v154
    v_or_b32 v187, -5, v154
    v_bitop3_b32 v186, v186, v187, 60 bitop3:0x80
    ds_add_rtn_u32 v209, v186, v225 offset:36864
    v_perm_b32 v155, v155, v154, s78
    v_add3_u32 v155, v155, v237, s82
    v_lshl_or_b32 v155, v154, 25, v155
    v_and_b32 v154, 0x003fff80, v154
K_ld13:
    s_mov_b64 exec, s[68:69]
    s_cbranch_execz K_ld14
    v_lshrrev_b32 v186, 1, v156
    v_or_b32 v187, -5, v156
    v_bitop3_b32 v186, v186, v187, 60 bitop3:0x80
    ds_add_rtn_u32 v210, v186, v225 offset:36864
    v_perm_b32 v157, v157, v156, s78
    v_add3_u32 v157, v157, v238, s82
    v_lshl_or_b32 v157, v156, 25, v157
    v_and_b32 v156, 0x003fff80, v156
K_ld14:
    s_mov_b64 exec, s[70:71]
    s_cbranch_execz K_ld15
    v_lshrrev_b32 v186, 1, v158
    v_or_b32 v187, -5, v158
    v_bitop3_b32 v186, v186, v187, 60 bitop3:0x80
    ds_add_rtn_u32 v211, v186, v225 offset:36864
    v_perm_b32 v159, v159, v158, s78
    v_add3_u32 v159, v159, v239, s82
    v_lshl_or_b32 v159, v158, 25, v159
    v_and_b32 v158, 0x003fff80, v158
K_ld15:
    s_mov_b64 exec, -1
    s_cmp_eq_u32 s0, 0
    s_cbranch_scc1 K_dry
    s_waitcnt lgkmcnt(0)
    v_min_u32_sdwa v208, v208, v226 dst_sel:WORD_0 dst_unused:UNUSED_PAD src0_sel:DWORD src1_sel:DWORD
    v_min_u32_sdwa v209, v209, v226 dst_sel:WORD_0 dst_unused:UNUSED_PAD src0_sel:DWORD src1_sel:DWORD
    v_min_u32_sdwa v210, v210, v226 dst_sel:WORD_0 dst_unused:UNUSED_PAD src0_sel:DWORD src1_sel:DWORD
    v_min_u32_sdwa v211, v211, v226 dst_sel:WORD_0 dst_unused:UNUSED_PAD src0_sel:DWORD src1_sel:DWORD
    ds_write2st64_b32 v208, v152, v153 offset0:128 offset1:221
    ds_write2st64_b32 v209, v154, v155 offset0:128 offset1:221
    ds_write2st64_b32 v210, v156, v157 offset0:128 offset1:221
    ds_write2st64_b32 v211, v158, v159 offset0:128 offset1:221
    s_branch K_cntdone
K_l2retry:
    s_sub_u32 s92, s92, 1
    s_cbranch_scc1 K_panic
    v_lshrrev_b32 v208, 1, v231
    s_lshl_b32 s3, s29, 14
    s_add_u32 s3, s3, 8388608
    s_mov_b64 exec, s[64:65]
    buffer_load_dwordx2 v[152:153], v208, s[12:15], s3 offen sc1
    s_lshl_b32 s3, s29, 14
    s_add_u32 s3, s3, 8392704
    s_mov_b64 exec, s[66:67]
    buffer_load_dwordx2 v[154:155], v208, s[12:15], s3 offen sc1
    s_lshl_b32 s3, s29, 14
    s_add_u32 s3, s3, 8396800
    s_mov_b64 exec, s[68:69]
    buffer_load_dwordx2 v[156:157], v208, s[12:15], s3 offen sc1
    s_lshl_b32 s3, s29, 14
    s_add_u32 s3, s3, 8400896
    s_mov_b64 exec, s[70:71]
    buffer_load_dwordx2 v[158:159], v208, s[12:15], s3 offen sc1
    s_mov_b64 exec, -1
    s_waitcnt vmcnt(0)
    s_branch K_late_chk
K_ovf:
    v_mov_b32 v141, v236
    s_mov_b32 exec_lo, 0x2020202
    s_mov_b32 exec_hi, exec_lo
    v_mov_b32 v141, v237
    v_mov_b32 v251, v252
    s_mov_b32 exec_lo, 0x4040404
    s_mov_b32 exec_hi, exec_lo
    v_mov_b32 v141, v238
    v_mov_b32 v251, v253
    s_mov_b32 exec_lo, 0x8080808
    s_mov_b32 exec_hi, exec_lo
    v_mov_b32 v141, v239
    v_mov_b32 v251, v254
    s_mov_b32 exec_lo, 0x0f0f0f0f
    s_mov_b32 exec_hi, exec_lo
    v_cmp_gt_i32 s[40:41], 0, v251
    s_mov_b64 exec, -1
    v_mov_b32 v140, 0x70
    s_mov_b32 s42, 0
K_ov1:
    s_ff1_i32_b64 s3, s[40:41]
    s_bitset0_b64 s[40:41], s3
    v_readlane_b32 s38, v141, s3
    v_lshlrev_b32 v136, 8, v255
    s_lshr_b32 s38, s38, 2
    s_nop 2
    buffer_load_dword v128, v136, s[24:27], s38 offen offset:0
    buffer_load_dword v129, v136, s[20:23], s38 offen offset:0
    buffer_load_dword v130, v136, s[24:27], s38 offen offset:128
    buffer_load_dword v131, v136, s[20:23], s38 offen offset:128
    s_mov_b32 s39, 13
    s_waitcnt vmcnt(0)
    v_lshlrev_b32 v136, 4, v255
    buffer_load_dwordx4 v[148:151], v136, s[24:27], s38 offen
    buffer_load_dwordx4 v[152:155], v136, s[20:23], s38 offen
K_ov2:
    v_mov_b64 v[196:197], -1
    v_mov_b64 v[198:199], -1
    s_waitcnt vmcnt(0)
    v_mov_b64 v[128:129], v[148:149]
    v_mov_b64 v[130:131], v[150:151]
    v_mov_b64 v[132:133], v[152:153]
    v_mov_b64 v[134:135], v[154:155]
    buffer_load_dwordx4 v[148:151], v136, s[24:27], s38 offen offset:1024
    buffer_load_dwordx4 v[152:155], v136, s[20:23], s38 offen offset:1024
    v_and_b32 v139, 255, v128
    v_add_u32 v128, 25088, v128
    v_lshrrev_b32 v138, 4, v128
    v_lshrrev_b32 v128, 11, v128
    v_bitop3_b32 v128, v140, v138, v128 bitop3:0xca
    v_lshrrev_b32 v137, 1, v128
    v_or_b32 v138, -5, v128
    v_bitop3_b32 v137, v137, v138, 60 bitop3:0x80
    s_add_u32 s3, s38, 0
    v_add_lshl_u32 v144, v136, s3, 2
    v_lshl_or_b32 v144, v128, 25, v144
    v_lshlrev_b32 v132, 7, v132
    v_cmpx_eq_u32 vcc, s29, v139
    v_cmpx_gt_u32 vcc, 12500, v136
    ds_add_rtn_u32 v196, v137, v225 offset:36864
    s_bcnt1_i32_b64 s3, vcc
    s_mov_b64 exec, -1
    s_add_u32 s42, s42, s3
    v_and_b32 v139, 255, v129
    v_add_u32 v129, 25088, v129
    v_lshrrev_b32 v138, 4, v129
    v_lshrrev_b32 v129, 11, v129
    v_bitop3_b32 v129, v140, v138, v129 bitop3:0xca
    v_lshrrev_b32 v137, 1, v129
    v_or_b32 v138, -5, v129
    v_bitop3_b32 v137, v137, v138, 60 bitop3:0x80
    s_add_u32 s3, s38, 4
    v_add_lshl_u32 v145, v136, s3, 2
    v_lshl_or_b32 v145, v129, 25, v145
    v_lshlrev_b32 v133, 7, v133
    v_cmpx_eq_u32 vcc, s29, v139
    v_cmpx_gt_u32 vcc, 12496, v136
    ds_add_rtn_u32 v197, v137, v225 offset:36864
    s_bcnt1_i32_b64 s3, vcc
    s_mov_b64 exec, -1
    s_add_u32 s42, s42, s3
    v_and_b32 v139, 255, v130
    v_add_u32 v130, 25088, v130
    v_lshrrev_b32 v138, 4, v130
    v_lshrrev_b32 v130, 11, v130
    v_bitop3_b32 v130, v140, v138, v130 bitop3:0xca
    v_lshrrev_b32 v137, 1, v130
    v_or_b32 v138, -5, v130
    v_bitop3_b32 v137, v137, v138, 60 bitop3:0x80
    s_add_u32 s3, s38, 8
    v_add_lshl_u32 v146, v136, s3, 2
    v_lshl_or_b32 v146, v130, 25, v146
    v_lshlrev_b32 v134, 7, v134
    v_cmpx_eq_u32 vcc, s29, v139
    v_cmpx_gt_u32 vcc, 12492, v136
    ds_add_rtn_u32 v198, v137, v225 offset:36864
    s_bcnt1_i32_b64 s3, vcc
    s_mov_b64 exec, -1
    s_add_u32 s42, s42, s3
    v_and_b32 v139, 255, v131
    v_add_u32 v131, 25088, v131
    v_lshrrev_b32 v138, 4, v131
    v_lshrrev_b32 v131, 11, v131
    v_bitop3_b32 v131, v140, v138, v131 bitop3:0xca
    v_lshrrev_b32 v137, 1, v131
    v_or_b32 v138, -5, v131
    v_bitop3_b32 v137, v137, v138, 60 bitop3:0x80
    s_add_u32 s3, s38, 12
    v_add_lshl_u32 v147, v136, s3, 2
    v_lshl_or_b32 v147, v131, 25, v147
    v_lshlrev_b32 v135, 7, v135
    v_cmpx_eq_u32 vcc, s29, v139
    v_cmpx_gt_u32 vcc, 12488, v136
    ds_add_rtn_u32 v199, v137, v225 offset:36864
    s_bcnt1_i32_b64 s3, vcc
    s_mov_b64 exec, -1
    s_add_u32 s42, s42, s3
    s_waitcnt lgkmcnt(0)
    v_min_u32_sdwa v196, v196, v226 dst_sel:WORD_0 dst_unused:UNUSED_PAD src0_sel:DWORD src1_sel:DWORD
    v_min_u32_sdwa v197, v197, v226 dst_sel:WORD_0 dst_unused:UNUSED_PAD src0_sel:DWORD src1_sel:DWORD
    v_min_u32_sdwa v198, v198, v226 dst_sel:WORD_0 dst_unused:UNUSED_PAD src0_sel:DWORD src1_sel:DWORD
    v_min_u32_sdwa v199, v199, v226 dst_sel:WORD_0 dst_unused:UNUSED_PAD src0_sel:DWORD src1_sel:DWORD
    ds_write2st64_b32 v196, v132, v144 offset0:128 offset1:221
    ds_write2st64_b32 v197, v133, v145 offset0:128 offset1:221
    ds_write2st64_b32 v198, v134, v146 offset0:128 offset1:221
    ds_write2st64_b32 v199, v135, v147 offset0:128 offset1:221
    v_add_u32 v136, 1024, v136
    s_cmp_gt_u32 s42, 256
    s_cbranch_scc1 K_panic
    s_sub_u32 s39, s39, 1
    s_cmp_lg_u32 s39, 0
    s_waitcnt lgkmcnt(0)
    s_cbranch_scc1 K_ov2
    s_waitcnt vmcnt(0)
    s_cmp_lg_u64 s[40:41], 0
    s_cbranch_scc1 K_ov1
K_last:
    s_branch K_ovf_r
K_panic:
    s_mov_b64 exec, -1
    s_waitcnt vmcnt(0)
    v_mov_b32 v208, 0x10000000
    ds_max_u32 v250, v208 offset:36864
    s_branch K_cntdone
K_slow_init:
    s_waitcnt vmcnt(0) lgkmcnt(0)
    s_cmp_eq_u32 s77, 0
    s_cselect_b64 exec, 0, -1
    ds_write_b16 v241, v250
    s_mov_b64 exec, -1
    s_cmp_lt_u32 s28, 4
    s_cbranch_scc1 K_nosbb
    v_permlane32_swap_b32 v64, v66
    v_permlane32_swap_b32 v65, v67
    v_permlane32_swap_b32 v68, v70
    v_permlane32_swap_b32 v69, v71
    v_permlane32_swap_b32 v72, v74
    v_permlane32_swap_b32 v73, v75
    v_permlane32_swap_b32 v76, v78
    v_permlane32_swap_b32 v77, v79
    v_permlane32_swap_b32 v80, v82
    v_permlane32_swap_b32 v81, v83
    v_permlane32_swap_b32 v84, v86
    v_permlane32_swap_b32 v85, v87
    v_permlane32_swap_b32 v88, v90
    v_permlane32_swap_b32 v89, v91
    v_permlane32_swap_b32 v92, v94
    v_permlane32_swap_b32 v93, v95
    v_mov_b64 v[96:97], 0
    v_mov_b64 v[98:99], 0
    v_mov_b64 v[100:101], 0
    v_mov_b64 v[102:103], 0
    v_mov_b64 v[104:105], 0
    v_mov_b64 v[106:107], 0
    v_mov_b64 v[108:109], 0
    v_mov_b64 v[110:111], 0
    v_mov_b64 v[112:113], 0
    v_mov_b64 v[114:115], 0
    v_mov_b64 v[116:117], 0
    v_mov_b64 v[118:119], 0
    v_mov_b64 v[120:121], 0
    v_mov_b64 v[122:123], 0
    v_mov_b64 v[124:125], 0
    v_mov_b64 v[126:127], 0
    s_and_b32 s38, s28, 3
    v_lshrrev_b32 v214, 3, v255
    s_lshl_b32 s3, s28, 2
    v_and_b32 v251, 3, v255
    s_lshr_b32 s39, 0x1325467, s3
    v_mul_f32 v214, 0x43840000, v214
    s_and_b32 s39, s39, 7
    v_and_b32 v252, 4, v255
    s_mov_b32 s58, 0xf000f000
    v_fmamk_f32 v214, v251, 0x41800000, v214
    s_mov_b32 s59, s58
    v_and_b32 v215, 96, v242
    s_cmp_lt_u32 s38, 2
    v_fmamk_f32 v214, v252, 0x42000000, v214
    s_mov_b32 s56, 0xf000f0
    v_fmamk_f32 v251, v251, 0x43880000, v215
    s_cselect_b32 s56, 0xe000e0, s56
    v_and_b32 v252, 8, v255
    s_mov_b32 s57, s56
    v_fmamk_f32 v251, v252, 0x43080000, v251
    s_sub_u32 s3, m0, 1536
    v_add_u32 v219, s3, v251
    s_xor_b32 s3, s28, 4
    v_mov_b32 v216, s3
    s_max_u32 s3, s39, s28
    v_mov_b32 v217, s38
    s_mov_b64 exec, s[58:59]
    v_mov_b32 v216, s39
    v_mov_b32 v217, s3
    s_mov_b64 exec, -1
    v_fmamk_f32 v216, v216, 0x45210000, v251
    v_mul_f32 v217, 4.0, v217
    v_cmp_gt_u32 s[86:87], s18, v228
    v_mov_b32 v213, 1
    s_or_b64 s[38:39], s[56:57], s[58:59]
    v_mov_b32 v218, 0
    s_andn2_b64 s[86:87], s[86:87], s[38:39]
K_nosbb:
    v_lshrrev_b32 v253, 4, v255
    s_mul_i32 s3, s28, 2112
    v_lshl_add_u32 v252, v255, 4, s3
    v_fmamk_f32 v252, v253, 0x41000000, v252
    v_lshlrev_b32 v253, s28, v213
    ds_write_b128 v252, v[176:179] offset:16384
    ds_write_b128 v252, v[232:235] offset:17440
    s_mov_b64 exec, 1
    ds_or_b32 v250, v253 offset:36960
    s_mov_b64 exec, -1
    s_mov_b32 s83, 1
    s_mov_b32 s84, 0
K_scan0:
    s_mov_b32 s81, s54
    v_lshlrev_b32 v136, 4, v255
    v_mov_b32 v140, 0x70
    s_lshl_b32 s78, s1, 3
    s_sub_u32 s79, s63, 45712
    s_mul_i32 s79, s79, 171
    s_lshr_b32 s79, s79, 17
    s_lshl_b32 s79, s79, 3
    s_add_u32 s79, s79, 4
K_scan:
    buffer_load_dwordx4 v[128:131], v136, s[24:27], s84 offen
    buffer_load_dwordx4 v[132:135], v136, s[20:23], s84 offen
    s_waitcnt vmcnt(0)
    v_and_b32 v138, 255, v128
    v_cmp_eq_u32 s[40:41], s29, v138
    v_add_u32 v128, 25088, v128
    v_lshrrev_b32 v138, 4, v128
    v_lshrrev_b32 v128, 11, v128
    v_bitop3_b32 v128, v140, v138, v128 bitop3:0xca
    v_lshrrev_b32 v137, 1, v128
    v_or_b32 v138, -5, v128
    v_bitop3_b32 v137, v137, v138, 60 bitop3:0x80
    v_cmp_eq_u32 s[42:43], s78, v137
    v_cmp_eq_u32 vcc, s79, v137
    s_add_u32 s3, s84, 0
    v_add_lshl_u32 v139, v136, s3, 2
    v_lshl_or_b32 v139, v128, 25, v139
    v_add_u32 v138, s93, v139
    v_cndmask_b32 v139, v139, v138, vcc
    s_or_b64 vcc, vcc, s[42:43]
    s_and_b64 vcc, vcc, s[40:41]
    v_mbcnt_lo_u32_b32 v138, vcc_lo, 0
    v_mbcnt_hi_u32_b32 v138, vcc_hi, v138
    v_lshl_add_u32 v138, v138, 2, s81
    v_lshlrev_b32 v132, 7, v132
    s_mov_b64 exec, vcc
    ds_write2st64_b32 v138, v132, v139 offset0:128 offset1:221
    s_mov_b64 exec, -1
    s_bcnt1_i32_b64 s3, vcc
    s_lshl2_add_u32 s81, s3, s81
    v_and_b32 v138, 255, v129
    v_cmp_eq_u32 s[40:41], s29, v138
    v_add_u32 v129, 25088, v129
    v_lshrrev_b32 v138, 4, v129
    v_lshrrev_b32 v129, 11, v129
    v_bitop3_b32 v129, v140, v138, v129 bitop3:0xca
    v_lshrrev_b32 v137, 1, v129
    v_or_b32 v138, -5, v129
    v_bitop3_b32 v137, v137, v138, 60 bitop3:0x80
    v_cmp_eq_u32 s[42:43], s78, v137
    v_cmp_eq_u32 vcc, s79, v137
    s_add_u32 s3, s84, 4
    v_add_lshl_u32 v139, v136, s3, 2
    v_lshl_or_b32 v139, v129, 25, v139
    v_add_u32 v138, s93, v139
    v_cndmask_b32 v139, v139, v138, vcc
    s_or_b64 vcc, vcc, s[42:43]
    s_and_b64 vcc, vcc, s[40:41]
    v_mbcnt_lo_u32_b32 v138, vcc_lo, 0
    v_mbcnt_hi_u32_b32 v138, vcc_hi, v138
    v_lshl_add_u32 v138, v138, 2, s81
    v_lshlrev_b32 v133, 7, v133
    s_mov_b64 exec, vcc
    ds_write2st64_b32 v138, v133, v139 offset0:128 offset1:221
    s_mov_b64 exec, -1
    s_bcnt1_i32_b64 s3, vcc
    s_lshl2_add_u32 s81, s3, s81
    v_and_b32 v138, 255, v130
    v_cmp_eq_u32 s[40:41], s29, v138
    v_add_u32 v130, 25088, v130
    v_lshrrev_b32 v138, 4, v130
    v_lshrrev_b32 v130, 11, v130
    v_bitop3_b32 v130, v140, v138, v130 bitop3:0xca
    v_lshrrev_b32 v137, 1, v130
    v_or_b32 v138, -5, v130
    v_bitop3_b32 v137, v137, v138, 60 bitop3:0x80
    v_cmp_eq_u32 s[42:43], s78, v137
    v_cmp_eq_u32 vcc, s79, v137
    s_add_u32 s3, s84, 8
    v_add_lshl_u32 v139, v136, s3, 2
    v_lshl_or_b32 v139, v130, 25, v139
    v_add_u32 v138, s93, v139
    v_cndmask_b32 v139, v139, v138, vcc
    s_or_b64 vcc, vcc, s[42:43]
    s_and_b64 vcc, vcc, s[40:41]
    v_mbcnt_lo_u32_b32 v138, vcc_lo, 0
    v_mbcnt_hi_u32_b32 v138, vcc_hi, v138
    v_lshl_add_u32 v138, v138, 2, s81
    v_lshlrev_b32 v134, 7, v134
    s_mov_b64 exec, vcc
    ds_write2st64_b32 v138, v134, v139 offset0:128 offset1:221
    s_mov_b64 exec, -1
    s_bcnt1_i32_b64 s3, vcc
    s_lshl2_add_u32 s81, s3, s81
    v_and_b32 v138, 255, v131
    v_cmp_eq_u32 s[40:41], s29, v138
    v_add_u32 v131, 25088, v131
    v_lshrrev_b32 v138, 4, v131
    v_lshrrev_b32 v131, 11, v131
    v_bitop3_b32 v131, v140, v138, v131 bitop3:0xca
    v_lshrrev_b32 v137, 1, v131
    v_or_b32 v138, -5, v131
    v_bitop3_b32 v137, v137, v138, 60 bitop3:0x80
    v_cmp_eq_u32 s[42:43], s78, v137
    v_cmp_eq_u32 vcc, s79, v137
    s_add_u32 s3, s84, 12
    v_add_lshl_u32 v139, v136, s3, 2
    v_lshl_or_b32 v139, v131, 25, v139
    v_add_u32 v138, s93, v139
    v_cndmask_b32 v139, v139, v138, vcc
    s_or_b64 vcc, vcc, s[42:43]
    s_and_b64 vcc, vcc, s[40:41]
    v_mbcnt_lo_u32_b32 v138, vcc_lo, 0
    v_mbcnt_hi_u32_b32 v138, vcc_hi, v138
    v_lshl_add_u32 v138, v138, 2, s81
    v_lshlrev_b32 v135, 7, v135
    s_mov_b64 exec, vcc
    ds_write2st64_b32 v138, v135, v139 offset0:128 offset1:221
    s_mov_b64 exec, -1
    s_bcnt1_i32_b64 s3, vcc
    s_lshl2_add_u32 s81, s3, s81
    s_add_u32 s84, s84, 1024
    s_sub_u32 s76, s81, s54
    s_cmp_ge_u32 s84, 3200000
    s_cbranch_scc1 K_flush
    s_cmp_le_u32 s76, 1024
    s_cbranch_scc1 K_scan
K_flush:
    v_lshl_add_u32 v138, v255, 2, s81
    v_mov_b32 v137, 4194176
    v_mov_b32 v139, s37
    s_cmp_lt_u32 s76, 256
    s_cselect_b32 exec_hi, -1, 0
    ds_write2st64_b32 v138, v137, v139 offset0:128 offset1:221
    s_mov_b64 exec, -1
    s_mul_i32 s3, s1, 2176
    v_and_b32 v248, 14, v255
    v_and_b32 v251, 12, v255
    s_add_u32 s3, s3, 61072
    v_fmaak_f32 v247, 4.0, v251, 0x5d00
    v_and_b32 v251, 34, v255
    v_lshl_add_u32 v248, v248, 3, s3
    v_fma_f32 v247, v251, 2.0, v247
    v_and_b32 v251, 16, v255
    v_fma_f32 v247, v251, 0.5, v247
    v_add_u32 v247, s3, v247
    s_mov_b32 s62, 0
    s_mov_b32 s77, 0
    s_mov_b32 s82, 0
    s_movk_i32 s78, 99
    s_add_u32 s76, s76, 124
    s_lshr_b32 s76, s76, 7
    s_cbranch_scc1 K_go
    s_branch K_epi
K_none:
    s_waitcnt vmcnt(0)
    s_cmp_lt_u32 s28, 4
    s_cbranch_scc1 K_nosbc
    v_permlane32_swap_b32 v64, v66
    v_permlane32_swap_b32 v65, v67
    v_permlane32_swap_b32 v68, v70
    v_permlane32_swap_b32 v69, v71
    v_permlane32_swap_b32 v72, v74
    v_permlane32_swap_b32 v73, v75
    v_permlane32_swap_b32 v76, v78
    v_permlane32_swap_b32 v77, v79
    v_permlane32_swap_b32 v80, v82
    v_permlane32_swap_b32 v81, v83
    v_permlane32_swap_b32 v84, v86
    v_permlane32_swap_b32 v85, v87
    v_permlane32_swap_b32 v88, v90
    v_permlane32_swap_b32 v89, v91
    v_permlane32_swap_b32 v92, v94
    v_permlane32_swap_b32 v93, v95
    v_mov_b64 v[96:97], 0
    v_mov_b64 v[98:99], 0
    v_mov_b64 v[100:101], 0
    v_mov_b64 v[102:103], 0
    v_mov_b64 v[104:105], 0
    v_mov_b64 v[106:107], 0
    v_mov_b64 v[108:109], 0
    v_mov_b64 v[110:111], 0
    v_mov_b64 v[112:113], 0
    v_mov_b64 v[114:115], 0
    v_mov_b64 v[116:117], 0
    v_mov_b64 v[118:119], 0
    v_mov_b64 v[120:121], 0
    v_mov_b64 v[122:123], 0
    v_mov_b64 v[124:125], 0
    v_mov_b64 v[126:127], 0
    s_and_b32 s38, s28, 3
    v_lshrrev_b32 v214, 3, v255
    s_lshl_b32 s3, s28, 2
    v_and_b32 v251, 3, v255
    s_lshr_b32 s39, 0x1325467, s3
    v_mul_f32 v214, 0x43840000, v214
    s_and_b32 s39, s39, 7
    v_and_b32 v252, 4, v255
    s_mov_b32 s58, 0xf000f000
    v_fmamk_f32 v214, v251, 0x41800000, v214
    s_mov_b32 s59, s58
    v_and_b32 v215, 96, v242
    s_cmp_lt_u32 s38, 2
    v_fmamk_f32 v214, v252, 0x42000000, v214
    s_mov_b32 s56, 0xf000f0
    v_fmamk_f32 v251, v251, 0x43880000, v215
    s_cselect_b32 s56, 0xe000e0, s56
    v_and_b32 v252, 8, v255
    s_mov_b32 s57, s56
    v_fmamk_f32 v251, v252, 0x43080000, v251
    s_sub_u32 s3, m0, 1536
    v_add_u32 v219, s3, v251
    s_xor_b32 s3, s28, 4
    v_mov_b32 v216, s3
    s_max_u32 s3, s39, s28
    v_mov_b32 v217, s38
    s_mov_b64 exec, s[58:59]
    v_mov_b32 v216, s39
    v_mov_b32 v217, s3
    s_mov_b64 exec, -1
    v_fmamk_f32 v216, v216, 0x45210000, v251
    v_mul_f32 v217, 4.0, v217
    v_cmp_gt_u32 s[86:87], s18, v228
    v_mov_b32 v213, 1
    s_or_b64 s[38:39], s[56:57], s[58:59]
    v_mov_b32 v218, 0
    s_andn2_b64 s[86:87], s[86:87], s[38:39]
K_nosbc:
    v_lshrrev_b32 v253, 4, v255
    s_mul_i32 s3, s28, 2112
    v_lshl_add_u32 v252, v255, 4, s3
    v_fmamk_f32 v252, v253, 0x41000000, v252
    v_lshlrev_b32 v253, s28, v213
    ds_write_b128 v252, v[176:179] offset:16384
    ds_write_b128 v252, v[232:235] offset:17440
    s_mov_b64 exec, 1
    ds_or_b32 v250, v253 offset:36960
    s_mov_b64 exec, -1
    s_branch K_epi
K_sdrain:
    s_waitcnt lgkmcnt(7)
    v_fma_f32 v225, v225, v209, v209
    v_bitop3_b32 v135, v135, v210, v134 bitop3:0xea
    v_bitop3_b32 v134, v133, v210, v132 bitop3:0xea
    v_bitop3_b32 v133, v131, v210, v130 bitop3:0xea
    v_or_b32 v132, v128, v129
    v_mfma_f32_16x16x32_bf16 v[152:155], v[180:183], v[56:59], 0
    v_rcp_f32 v224, v224
    v_mfma_f32_16x16x32_bf16 v[152:155], v[184:187], v[60:63], v[152:155]
    v_rcp_f32 v225, v225
    v_mfma_f32_16x16x32_bf16 v[152:155], v[196:199], v[92:95], v[152:155]
    v_mfma_f32_16x16x32_bf16 v[156:159], v[188:191], v[56:59], 0
    v_mfma_f32_16x16x32_bf16 v[156:159], v[192:195], v[60:63], v[156:159]
    v_mfma_f32_16x16x32_bf16 v[156:159], v[200:203], v[92:95], v[156:159]
    v_mfma_f32_16x16x32_bf16 v[112:115], v[132:135], v[204:207], v[112:115]
    v_exp_f32 v220, -v150
    v_exp_f32 v221, -v151
    v_or_b32_sdwa v145, s36, v145 dst_sel:DWORD dst_unused:UNUSED_PAD src0_sel:DWORD src1_sel:WORD_1
    v_or_b32_sdwa v146, s36, v146 dst_sel:DWORD dst_unused:UNUSED_PAD src0_sel:DWORD src1_sel:WORD_1
    v_or_b32_sdwa v147, s36, v147 dst_sel:DWORD dst_unused:UNUSED_PAD src0_sel:DWORD src1_sel:WORD_1
    v_or_b32_sdwa v148, s36, v148 dst_sel:DWORD dst_unused:UNUSED_PAD src0_sel:DWORD src1_sel:WORD_1
    v_or_b32_sdwa v149, s36, v149 dst_sel:DWORD dst_unused:UNUSED_PAD src0_sel:DWORD src1_sel:WORD_1
    v_mul_f32 v141, v224, v141
    ds_read_u16_d16_hi v145, v145 offset:48383
    ds_read_u16_d16 v146, v146 offset:48383
    ds_read_u16_d16_hi v147, v147 offset:48383
    ds_read_u16_d16 v148, v148 offset:48383
    ds_read_u16_d16_hi v149, v149 offset:48383
    s_waitcnt lgkmcnt(6)
    v_mul_f32 v143, v225, v143
    v_add_f32 v220, 1.0, v220
    v_add_f32 v221, 1.0, v221
    v_bitop3_b32 v143, v143, v210, v142 bitop3:0xea
    v_bitop3_b32 v142, v141, v210, v140 bitop3:0xea
    v_or_b32 v141, v138, v139
    v_or_b32 v140, v136, v137
    v_rcp_f32 v220, v220
    s_nop 0
    v_mfma_f32_16x16x32_bf16 v[116:119], v[140:143], v[204:207], v[116:119]
    v_rcp_f32 v221, v221
    v_exp_f32 v224, -v158
    v_exp_f32 v225, -v159
    v_or_b32_sdwa v152, s36, v152 dst_sel:DWORD dst_unused:UNUSED_PAD src0_sel:DWORD src1_sel:WORD_1
    v_or_b32_sdwa v153, s36, v153 dst_sel:DWORD dst_unused:UNUSED_PAD src0_sel:DWORD src1_sel:WORD_1
    v_or_b32_sdwa v154, s36, v154 dst_sel:DWORD dst_unused:UNUSED_PAD src0_sel:DWORD src1_sel:WORD_1
    v_or_b32_sdwa v155, s36, v155 dst_sel:DWORD dst_unused:UNUSED_PAD src0_sel:DWORD src1_sel:WORD_1
    v_or_b32_sdwa v156, s36, v156 dst_sel:DWORD dst_unused:UNUSED_PAD src0_sel:DWORD src1_sel:WORD_1
    v_or_b32_sdwa v157, s36, v157 dst_sel:DWORD dst_unused:UNUSED_PAD src0_sel:DWORD src1_sel:WORD_1
    v_mul_f32 v220, v220, v150
    ds_read_u16_d16 v152, v152 offset:48383
    ds_read_u16_d16_hi v153, v153 offset:48383
    ds_read_u16_d16 v154, v154 offset:48383
    ds_read_u16_d16_hi v155, v155 offset:48383
    ds_read_u16_d16 v156, v156 offset:48383
    ds_read_u16_d16_hi v157, v157 offset:48383
    s_waitcnt lgkmcnt(6)
    v_mul_f32 v221, v221, v151
    v_add_f32 v224, 1.0, v224
    v_add_f32 v225, 1.0, v225
    v_or_b32 v150, v148, v149
    v_or_b32 v149, v146, v147
    v_or_b32 v148, v144, v145
    v_cvt_pk_bf16_f32 v151, v220, v221
    v_rcp_f32 v224, v224
    v_rcp_f32 v225, v225
    v_mfma_f32_16x16x32_bf16 v[120:123], v[148:151], v[204:207], v[120:123]
    v_mul_f32 v224, v224, v158
    v_mul_f32 v225, v225, v159
    s_waitcnt lgkmcnt(0)
    v_or_b32 v158, v156, v157
    v_or_b32 v157, v154, v155
    v_or_b32 v156, v152, v153
    v_cvt_pk_bf16_f32 v159, v224, v225
    s_nop 1
    v_mfma_f32_16x16x32_bf16 v[124:127], v[156:159], v[204:207], v[124:127]
    ds_write_b16 v241, v250
    s_mov_b32 s6, 3200000
    s_mov_b32 s10, 25600000
    v_mov_b32 v212, v229
    s_nop 1
    v_permlane32_swap_b32 v229, v212
    v_add_u32 v229, v229, v212
    v_mov_b32 v212, v229
    s_nop 1
    v_permlane16_swap_b32 v229, v212
    v_add_u32 v229, v229, v212
    s_mov_b32 s3, 0xefdfbf7f
    v_mul_lo_u32 v229, s3, v229
    v_bfe_u32 v212, v229, 7, 16
    v_lshrrev_b32 v229, 23, v229
    v_add_u32 v212, v212, v229
    v_add_u32 v218, v218, v212
    v_mov_b32 v229, 0
    s_waitcnt vmcnt(0)
    s_cmp_lt_u32 s84, 3200000
    s_cbranch_scc1 K_scan0
K_epi:
    v_cvt_f32_u32 v212, v218
K_epi2:
    s_mov_b32 s3, 0x1000000
K_epi3:
    ds_read_b32 v176, v250 offset:36960
    s_sub_u32 s3, s3, 1
    s_cbranch_scc1 K_done
    s_waitcnt lgkmcnt(0)
    v_cmp_ne_u32 vcc, 255, v176
    s_nop 0
    s_cbranch_vccnz K_epi3
    ds_read_b128 v[160:163], v215 offset:39040
    ds_read_b128 v[164:167], v215 offset:39056
    ds_read_b128 v[168:171], v215 offset:39168
    ds_read_b128 v[172:175], v215 offset:39184
    ds_read_b64_tr_b16 v[0:1], v214 offset:16384
    ds_read_b64_tr_b16 v[2:3], v214 offset:18496
    ds_read_b64_tr_b16 v[4:5], v214 offset:16392
    ds_read_b64_tr_b16 v[6:7], v214 offset:18504
    ds_read_b64_tr_b16 v[8:9], v214 offset:16448
    ds_read_b64_tr_b16 v[10:11], v214 offset:18560
    ds_read_b64_tr_b16 v[12:13], v214 offset:16456
    ds_read_b64_tr_b16 v[14:15], v214 offset:18568
    ds_read_b64_tr_b16 v[16:17], v214 offset:20608
    ds_read_b64_tr_b16 v[18:19], v214 offset:22720
    ds_read_b64_tr_b16 v[20:21], v214 offset:20616
    ds_read_b64_tr_b16 v[22:23], v214 offset:22728
    ds_read_b64_tr_b16 v[24:25], v214 offset:20672
    ds_read_b64_tr_b16 v[26:27], v214 offset:22784
    ds_read_b64_tr_b16 v[28:29], v214 offset:20680
    ds_read_b64_tr_b16 v[30:31], v214 offset:22792
    ds_read_b64_tr_b16 v[32:33], v214 offset:24832
    ds_read_b64_tr_b16 v[34:35], v214 offset:26944
    ds_read_b64_tr_b16 v[36:37], v214 offset:24840
    ds_read_b64_tr_b16 v[38:39], v214 offset:26952
    ds_read_b64_tr_b16 v[40:41], v214 offset:24896
    ds_read_b64_tr_b16 v[42:43], v214 offset:27008
    ds_read_b64_tr_b16 v[44:45], v214 offset:24904
    ds_read_b64_tr_b16 v[46:47], v214 offset:27016
    ds_read_b64_tr_b16 v[48:49], v214 offset:29056
    ds_read_b64_tr_b16 v[50:51], v214 offset:31168
    ds_read_b64_tr_b16 v[52:53], v214 offset:29064
    ds_read_b64_tr_b16 v[54:55], v214 offset:31176
    ds_read_b64_tr_b16 v[56:57], v214 offset:29120
    ds_read_b64_tr_b16 v[58:59], v214 offset:31232
    ds_read_b64_tr_b16 v[60:61], v214 offset:29128
    ds_read_b64_tr_b16 v[62:63], v214 offset:31240
    v_cvt_pk_bf16_f32 v64, v96, v97
    v_cvt_pk_bf16_f32 v65, v98, v99
    v_cvt_pk_bf16_f32 v66, v100, v101
    v_cvt_pk_bf16_f32 v67, v102, v103
    v_cvt_pk_bf16_f32 v68, v104, v105
    v_cvt_pk_bf16_f32 v69, v106, v107
    v_cvt_pk_bf16_f32 v70, v108, v109
    v_cvt_pk_bf16_f32 v71, v110, v111
    v_cvt_pk_bf16_f32 v72, v112, v113
    v_cvt_pk_bf16_f32 v73, v114, v115
    v_cvt_pk_bf16_f32 v74, v116, v117
    v_cvt_pk_bf16_f32 v75, v118, v119
    v_cvt_pk_bf16_f32 v76, v120, v121
    v_cvt_pk_bf16_f32 v77, v122, v123
    v_cvt_pk_bf16_f32 v78, v124, v125
    v_cvt_pk_bf16_f32 v79, v126, v127
    s_waitcnt lgkmcnt(15)
    v_pk_mul_f32 v[160:161], v[160:161], v[212:213] op_sel_hi:[1,0]
    v_pk_mul_f32 v[162:163], v[162:163], v[212:213] op_sel_hi:[1,0]
    v_pk_mul_f32 v[164:165], v[164:165], v[212:213] op_sel_hi:[1,0]
    v_pk_mul_f32 v[166:167], v[166:167], v[212:213] op_sel_hi:[1,0]
    v_pk_mul_f32 v[168:169], v[168:169], v[212:213] op_sel_hi:[1,0]
    v_pk_mul_f32 v[170:171], v[170:171], v[212:213] op_sel_hi:[1,0]
    v_pk_mul_f32 v[172:173], v[172:173], v[212:213] op_sel_hi:[1,0]
    v_pk_mul_f32 v[174:175], v[174:175], v[212:213] op_sel_hi:[1,0]
    v_mfma_f32_16x16x32_bf16 v[160:163], v[0:3], v[64:67], v[160:163]
    v_mfma_f32_16x16x32_bf16 v[164:167], v[4:7], v[64:67], v[164:167]
    v_mfma_f32_16x16x32_bf16 v[168:171], v[8:11], v[64:67], v[168:171]
    v_mfma_f32_16x16x32_bf16 v[172:175], v[12:15], v[64:67], v[172:175]
    v_mfma_f32_16x16x32_bf16 v[160:163], v[16:19], v[68:71], v[160:163]
    v_mfma_f32_16x16x32_bf16 v[164:167], v[20:23], v[68:71], v[164:167]
    v_mfma_f32_16x16x32_bf16 v[168:171], v[24:27], v[68:71], v[168:171]
    v_mfma_f32_16x16x32_bf16 v[172:175], v[28:31], v[68:71], v[172:175]
    s_waitcnt lgkmcnt(8)
    v_mfma_f32_16x16x32_bf16 v[160:163], v[32:35], v[72:75], v[160:163]
    v_mfma_f32_16x16x32_bf16 v[164:167], v[36:39], v[72:75], v[164:167]
    v_mfma_f32_16x16x32_bf16 v[168:171], v[40:43], v[72:75], v[168:171]
    v_mfma_f32_16x16x32_bf16 v[172:175], v[44:47], v[72:75], v[172:175]
    s_waitcnt lgkmcnt(0)
    v_mfma_f32_16x16x32_bf16 v[160:163], v[48:51], v[76:79], v[160:163]
    v_mfma_f32_16x16x32_bf16 v[164:167], v[52:55], v[76:79], v[164:167]
    v_mfma_f32_16x16x32_bf16 v[168:171], v[56:59], v[76:79], v[168:171]
    v_mfma_f32_16x16x32_bf16 v[172:175], v[60:63], v[76:79], v[172:175]
    s_branch K_xch
.section .rodata,"a"
.p2align 6
.amdhsa_kernel standalone__edge_featured_mpnn_mpnn__graph_kernel
  .amdhsa_next_free_vgpr 256
  .amdhsa_next_free_sgpr 102
  .amdhsa_accum_offset 256
  .amdhsa_group_segment_fixed_size 0
  .amdhsa_kernarg_size 88
  .amdhsa_float_denorm_mode_32 3
  .amdhsa_user_sgpr_count 2
  .amdhsa_user_sgpr_kernarg_segment_ptr 1
  .amdhsa_system_sgpr_workgroup_id_x 1
.end_amdhsa_kernel
```
